```python
import torch

def _softmax(x, axis=-1):
    return torch.softmax(x, dim=axis)
def _gelu(x):
    return torch.nn.functional.gelu(x, approximate="tanh")
def _silu(x):
    return torch.nn.functional.silu(x)
def _sigmoid(x):
    return torch.sigmoid(x)
def _layernorm(x, axis=-1, eps=1e-5):
    m = x.mean(dim=axis, keepdim=True)
    v = x.var(dim=axis, keepdim=True, unbiased=False)
    return (x - m) / torch.sqrt(v + eps)
def _scatter_add(tgt, idx, src, axis=0):
    return tgt.clone().index_add_(axis, idx, src)
def _segment_sum(src, seg, n):
    out = torch.zeros((n,) + src.shape[1:], dtype=src.dtype)
    return out.index_add_(0, seg, src)
def _pad(x, pw):
    flat = tuple(v for pair in reversed(pw) for v in pair)
    return torch.nn.functional.pad(x, flat)

kernel_name = 'concat_heads__sliding_block__ssm_conv_h3__prompt'

def setup_inputs():

    _w = (lambda a: (lambda t: t.to(torch.bfloat16) if t.is_floating_point() else t)(torch.as_tensor(a)))
    def _A_setup():
        B, S, D = 1, 2048, 640
        return {
            "x": _w((lambda *s: torch.randn(*s, dtype=torch.bfloat16) * 0.2)(B, S, D)),
            "wqkv": _w((lambda *s: torch.randn(*s, dtype=torch.bfloat16) * 0.2)(D, 3 * D)),
            "wo": _w((lambda *s: torch.randn(*s, dtype=torch.bfloat16) * 0.05)(D, D)),
        }
    _A_in = _A_setup()

    def _B_setup():
        B, S, D = 1, 2048, 640
        ks = 4
        return {
            "q": _w((lambda *s: torch.randn(*s, dtype=torch.bfloat16) * 0.05)(B, S, D)),
            "k": _w((lambda *s: torch.randn(*s, dtype=torch.bfloat16) * 0.8)(B, S, D)),
            "v": _w((lambda *s: torch.randn(*s, dtype=torch.bfloat16) * 0.8)(B, S, D)),
            "shift_k": _w((lambda *s: torch.randn(*s, dtype=torch.bfloat16) * 0.8)(D, ks) * 0.5),
            "ssm_k": _w((lambda *s: torch.randn(*s, dtype=torch.bfloat16) * 3.2)(D, S) * (1.0 / S ** 0.5)),
            "ssm_D": _w((lambda *s: torch.randn(*s, dtype=torch.bfloat16) * 0.8)(D)),
        }
    _B_in = _B_setup()

    return {
        "A_x": _A_in["x"],
        "A_wqkv": _A_in["wqkv"],
        "A_wo": _A_in["wo"],
        "B_q": _B_in["q"],
        "B_k": _B_in["k"],
        "B_v": _B_in["v"],
        "B_shift_k": _B_in["shift_k"],
        "B_ssm_k": _B_in["ssm_k"],
        "B_ssm_D": _B_in["ssm_D"],
    }

def reference(A_x, A_wqkv, A_wo, B_q, B_k, B_v, B_shift_k, B_ssm_k, B_ssm_D):
    def _A_ref(x, wqkv, wo):
        B, S, D = x.shape
        H = 32; Dh = D // H; W = 256
        qkv = (lambda x, *d: x.permute(*d))((x @ wqkv).reshape(B, S, 3, H, Dh), 2, 0, 3, 1, 4)
        q, k, v = qkv[0], qkv[1], qkv[2]
        scores = torch.einsum("bhqd,bhkd->bhqk", q, k) * (Dh ** -0.5)
        idx = torch.arange(S)
        mask = (idx[:, None] - idx[None, :] >= 0) & (idx[:, None] - idx[None, :] < W)
        scores = torch.where(mask[None, None], scores, -1e9)
        p = _softmax(scores, axis=-1)
        o = torch.einsum("bhqk,bhkd->bhqd", p, v)
        return (lambda x, *d: x.permute(*d))(o, 0, 2, 1, 3).reshape(B, S, D) @ wo

    def _B_ref(q, k, v, shift_k, ssm_k, ssm_D):
        B, S, D = q.shape
        ks = shift_k.shape[-1]
        k_pad = _pad(k, ((0, 0), (ks - 1, 0), (0, 0)))
        k_shift = torch.zeros_like(k)
        for t in range(ks):
            k_shift = k_shift + k_pad[:, t:t + S, :] * shift_k[:, ks - 1 - t][None, None, :]
        kv = k_shift * v
        L = 2 * S
        kv_pad = _pad(kv, ((0, 0), (0, S), (0, 0)))
        kf_pad = _pad(ssm_k, ((0, 0), (0, S)))
        kv_f = (lambda x, axes=(-2,-1): torch.fft.rfft2(x.float(), dim=axes))(kv_pad[:, None, :, :], axes=(1, 2))
        kf_f = (lambda x, axes=(-2,-1): torch.fft.rfft2(x.float(), dim=axes))(kf_pad[:, None, :], axes=(1, 2))
        kf_f = (lambda x, *d: x.permute(*d))(kf_f, 1, 2, 0)
        y_f = kv_f * kf_f[None, :, :, :]
        y = (lambda x, s, axes=(-2,-1): torch.fft.irfft2(x, s=s, dim=axes).to(torch.bfloat16))(y_f, (1, L), axes=(1, 2))[:, 0, :S, :]
        y = y + kv * ssm_D[None, None, :]
        return q * y

    a = _A_ref(A_x, A_wqkv, A_wo)
    b = _B_ref(B_q, B_k, B_v, B_shift_k, B_ssm_k, B_ssm_D)
    return torch.concatenate([a, b], axis=-1)
```

```asm
; @launch grid=(256,1,1) block=(512,1,1) lds=163840
.amdgcn_target "amdgcn-amd-amdhsa--gfx950"
.text
.globl concat_heads__sliding_block__ssm_conv_h3__prompt_kernel
.p2align 8
.type concat_heads__sliding_block__ssm_conv_h3__prompt_kernel,@function
concat_heads__sliding_block__ssm_conv_h3__prompt_kernel:
    s_cmp_ge_u32 s2, 256
    s_cbranch_scc1 .Lexit
    s_load_dwordx16 s[16:31], s[0:1], 0
    s_load_dwordx8 s[32:39], s[0:1], 64
    v_lshrrev_b32 v1, 6, v0
    v_and_b32 v0, 63, v0
    v_readfirstlane_b32 s3, v1
    s_and_b32 s4, s2, 7
    s_lshr_b32 s5, s2, 3
    s_getpc_b64 s[66:67]
    s_and_b32 s68, s2, 0xf8
    s_add_u32 s68, s68, s3
    s_lshl_b32 s68, s68, 7
    s_load_dword s100, s[66:67], s68
    s_add_u32 s68, s68, 64
    s_load_dword s100, s[66:67], s68
    s_lshr_b32 s67, s4, 2
    s_and_b32 s68, s4, 3
    s_cmp_eq_u32 s68, 3
    s_cbranch_scc1 .Lmap3
    s_cmp_ge_u32 s5, 26
    s_cbranch_scc1 .Lfree_a
    s_mul_i32 s66, s67, 26
    s_add_u32 s66, s66, s5
    s_mul_i32 s8, s68, 48
    s_add_u32 s8, s8, s66
    s_add_u32 s8, s8, 128
    s_lshr_b32 s6, s66, 2
    s_and_b32 s66, s66, 3
    s_lshl_b32 s7, s68, 2
    s_add_u32 s7, s7, s66
.Lmapd:
    s_mul_i32 s66, s7, 1
    s_mul_i32 s9, s6, 8
    s_add_u32 s9, s9, s67
    s_add_u32 s9, s9, s66
    s_mul_i32 s66, s9, 205
    s_lshr_b32 s66, s66, 11
    s_mul_i32 s66, s66, 10
    s_sub_u32 s9, s9, s66
    s_cmp_lt_u32 s3, 4
    s_cbranch_scc1 .Lawave
    s_sub_u32 s71, s3, 4
    v_lshrrev_b32 v6, 4, v0
    s_lshl_b32 s66, s71, 4
    v_add_u32 v7, s66, v6
    v_mul_u32_u24 v1, 3840, v7
    v_lshlrev_b32 v7, 2, v6
    v_and_b32 v8, 15, v0
    v_xor_b32 v7, v7, v8
    v_lshlrev_b32 v7, 4, v7
    s_lshl_b32 s66, s7, 8
    v_add3_u32 v1, v1, v7, s66
    v_xor_b32 v5, 32, v1
    v_lshrrev_b32 v7, 3, v0
    s_mul_i32 s66, s6, 160
    v_add_u32 v7, s66, v7
    v_mul_u32_u24 v7, 1280, v7
    v_and_b32 v8, 7, v0
    v_xor_b32 v8, v8, v6
    v_lshl_add_u32 v7, v8, 4, v7
    s_and_b32 s67, s71, 1
    s_lshl_b32 s67, s67, 6
    v_xor_b32 v7, s67, v7
    s_mul_i32 s66, s71, 30720
    v_add_u32 v2, s66, v7
    v_xor_b32 v3, 64, v2
    v_add_u32 v3, 10240, v3
    v_add_u32 v4, 20480, v2
    s_mul_i32 s12, s71, 3072
    s_mul_i32 s10, s9, 245760
    s_lshl_b32 s11, s9, 7
    s_lshl_b32 s13, s71, 12
    s_waitcnt lgkmcnt(0)
    s_mov_b32 s40, s16
    s_mov_b32 s41, s17
    s_mov_b32 s42, 2621440
    s_mov_b32 s43, 0x20000
    s_mov_b32 s44, s18
    s_mov_b32 s45, s19
    s_mov_b32 s46, 2457600
    s_mov_b32 s47, 0x20000
    s_add_u32 m0, s12, 16384
    s_nop 0
    buffer_load_dwordx4 v2, s[40:43], s11 offen lds
    s_add_u32 m0, s12, 17408
    s_nop 0
    buffer_load_dwordx4 v3, s[40:43], s11 offen lds
    s_add_u32 m0, s12, 18432
    s_nop 0
    buffer_load_dwordx4 v4, s[40:43], s11 offen lds
    s_add_u32 m0, s13, 0
    s_nop 0
    buffer_load_dwordx4 v1, s[44:47], s10 offen lds
    s_add_u32 m0, s13, 1024
    s_add_u32 s66, s10, 15360
    buffer_load_dwordx4 v1, s[44:47], s66 offen lds
    s_add_u32 m0, s13, 2048
    s_add_u32 s66, s10, 30720
    buffer_load_dwordx4 v5, s[44:47], s66 offen lds
    s_add_u32 m0, s13, 3072
    s_add_u32 s66, s10, 46080
    buffer_load_dwordx4 v5, s[44:47], s66 offen lds
    s_add_u32 s10, s10, 245760
    s_add_u32 s11, s11, 128
    s_cmp_eq_u32 s11, 1280
    s_cselect_b32 s10, 0, s10
    s_cselect_b32 s11, 0, s11
    s_cmp_lt_u32 s7, 12
    s_cselect_b32 s0, 8, 4
    s_cmp_eq_u32 s6, 12
    s_cselect_b32 s0, s0, 4
    s_lshl_b32 s68, s7, 1
    s_add_u32 s68, s68, 104
    s_cmp_eq_u32 s0, 8
    s_cselect_b32 s8, s68, s8
    s_lshl_b32 s8, s8, 1
    s_and_b32 s9, s71, 2
    s_cmp_eq_u32 s0, 8
    s_cselect_b32 s9, 0, s9
    s_add_u32 s8, s8, s71
    s_sub_u32 s8, s8, s9
    s_mov_b32 s60, s30
    s_mov_b32 s61, s31
    s_mov_b32 s62, 2621440
    s_mov_b32 s63, 0x20000
    s_lshl_b32 s66, s8, 12
    s_cmp_eq_u32 s9, 0
    s_cselect_b32 s66, s66, 1073741824
    v_lshlrev_b32 v15, 4, v0
    buffer_load_dwordx4 v[216:219], v15, s[60:63], s66 offen offset:0 nt
    buffer_load_dwordx4 v[220:223], v15, s[60:63], s66 offen offset:1024 nt
    buffer_load_dwordx4 v[224:227], v15, s[60:63], s66 offen offset:2048 nt
    buffer_load_dwordx4 v[228:231], v15, s[60:63], s66 offen offset:3072 nt
    s_lshr_b32 s67, s8, 1
    s_lshl_b32 s67, s67, 2
    s_load_dword s1, s[32:33], s67
    s_lshl_b32 s66, s7, 2
    s_add_u32 s66, s66, s71
    s_mul_i32 s66, s66, 1408
    s_mul_i32 s67, s6, 204800
    s_add_u32 s66, s66, s67
    s_add_u32 s66, s66, 122880
    v_min_u32 v11, 10, v0
    v_lshlrev_b32 v11, 7, v11
    buffer_load_dword v182, v11, s[40:43], s66 offen
    s_and_b32 s66, s5, 7
    s_mul_i32 s66, s66, 20
    s_add_u32 s66, s66, s71
    s_lshl_b32 s66, s66, 7
    s_add_u32 s66, s66, 14931456
    v_min_u32 v197, 4, v0
    v_lshl_add_u32 v197, v197, 9, s66
    v_and_b32 v200, 15, v0
    v_lshrrev_b32 v201, 4, v0
    v_lshl_add_u32 v211, v200, 1, v201
    s_lshl_b32 s66, s9, 3
    s_sub_u32 s66, 30, s66
    v_add_u32 v211, s66, v211
    v_lshlrev_b32 v210, 6, v211
    v_add_u32 v210, 145152, v210
    v_lshlrev_b32 v211, 2, v211
    v_lshlrev_b32 v202, 3, v201
    v_sub_u32 v202, v200, v202
    v_add_u32 v202, 25, v202
    v_and_b32 v203, 1, v202
    v_mul_u32_u24 v203, 4160, v203
    v_lshrrev_b32 v202, 1, v202
    v_lshl_add_u32 v202, v202, 2, v203
    s_sub_u32 s67, s71, s9
    s_mul_i32 s67, s67, 8320
    s_lshl_b32 s66, s9, 7
    s_add_u32 s66, s66, s67
    s_add_u32 s66, s66, 111872
    v_add_u32 v205, s66, v202
    v_add_u32 v206, 1024, v205
    v_add_u32 v207, 2048, v205
    v_add_u32 v208, 3072, v205
    v_and_b32 v202, 7, v200
    v_sub_u32 v202, 7, v202
    v_and_b32 v203, 1, v202
    v_lshlrev_b32 v203, 4, v203
    v_mov_b32 v204, 0xffff
    v_lshlrev_b32 v203, v203, v204
    v_lshrrev_b32 v204, 3, v200
    v_add_u32 v204, 2, v204
    v_cmp_eq_u32 vcc, v204, v201
    v_lshrrev_b32 v202, 1, v202
    s_nop 0
    v_cndmask_b32 v203, 0, v203, vcc
    v_cmp_eq_u32 vcc, 0, v202
    s_nop 1
    v_cndmask_b32 v176, 0, v203, vcc
    v_cmp_eq_u32 vcc, 1, v202
    s_nop 1
    v_cndmask_b32 v177, 0, v203, vcc
    v_cmp_eq_u32 vcc, 2, v202
    s_nop 1
    v_cndmask_b32 v178, 0, v203, vcc
    v_cmp_eq_u32 vcc, 3, v202
    s_nop 1
    v_cndmask_b32 v179, 0, v203, vcc
    v_and_b32 v212, 1, v201
    v_lshlrev_b32 v212, 9, v212
    v_lshrrev_b32 v202, 1, v201
    v_lshl_add_u32 v212, v202, 6, v212
    v_lshrrev_b32 v202, 2, v200
    v_lshl_add_u32 v212, v202, 7, v212
    v_and_b32 v202, 3, v200
    v_lshl_add_u32 v212, v202, 4, v212
    s_mul_i32 s66, s71, 13
    s_sub_u32 s66, s66, 1
    s_max_i32 s66, s66, 0
    s_lshl_b32 s66, s66, 7
    s_add_u32 s66, s66, 14879744
    v_lshl_add_u32 v213, v0, 7, s66
    v_lshrrev_b32 v202, 2, v0
    v_mul_u32_u24 v202, 10368, v202
    v_xor_b32 v203, v201, v0
    v_and_b32 v203, 3, v203
    v_lshl_add_u32 v202, v203, 4, v202
    s_mul_i32 s66, s71, 663552
    s_lshr_b32 s67, s8, 2
    s_lshl_b32 s67, s67, 6
    s_add_u32 s66, s66, s67
    v_add_u32 v214, s66, v202
    v_cmp_lt_u32 vcc, 19, v0
    s_nop 1
    v_cndmask_b32 v192, 0, 1, vcc
    v_mul_u32_u24 v201, 20, v192
    v_sub_u32 v201, v0, v201
    s_lshl_b32 s67, s71, 4
    v_lshl_add_u32 v202, v192, 6, s67
    v_and_b32 v203, 7, v201
    v_lshlrev_b32 v203, 4, v203
    v_xor_b32 v202, v202, v203
    v_lshl_add_u32 v202, v201, 9, v202
    v_add_u32 v193, 152064, v202
    s_lshl_b32 s67, s71, 1
    v_add_u32 v192, s67, v192
    v_mul_u32_u24 v192, 10240, v192
    v_lshlrev_b32 v201, 3, v201
    v_mov_b32 v203, 1073741824
    v_cmp_gt_u32 vcc, 40, v0
    s_nop 1
    v_cndmask_b32 v201, v203, v201, vcc
    v_lshl_add_u32 v195, v192, 1, v201
    v_add_u32 v192, v192, v201
    s_mul_i32 s67, s71, 20
    v_lshrrev_b32 v201, 3, v0
    s_add_u32 s68, s67, 0
    v_add_u32 v202, s68, v201
    v_lshrrev_b32 v203, 2, v202
    v_xor_b32 v203, v203, v0
    v_and_b32 v203, 7, v203
    v_lshlrev_b32 v202, 12, v202
    v_lshl_add_u32 v189, v203, 4, v202
    s_add_u32 s68, s67, 8
    v_add_u32 v202, s68, v201
    v_lshrrev_b32 v203, 2, v202
    v_xor_b32 v203, v203, v0
    v_and_b32 v203, 7, v203
    v_lshlrev_b32 v202, 12, v202
    v_lshl_add_u32 v190, v203, 4, v202
    s_add_u32 s68, s67, 16
    v_add_u32 v202, s68, v201
    v_lshrrev_b32 v203, 2, v202
    v_xor_b32 v203, v203, v0
    v_and_b32 v203, 7, v203
    v_lshlrev_b32 v202, 12, v202
    v_lshl_add_u32 v191, v203, 4, v202
    s_and_b32 s66, s5, 7
    s_mul_i32 s66, s66, 40
    s_mul_i32 s67, s71, 10
    s_add_u32 s66, s66, s67
    s_lshl_b32 s66, s66, 7
    s_add_u32 s66, s66, 14886400
    v_lshl_add_u32 v194, v0, 7, s66
    v_mov_b32 v196, 0xffff0000
    s_add_u32 m0, s12, 45056
    s_nop 0
    buffer_load_dwordx4 v2, s[40:43], s11 offen lds
    s_add_u32 m0, s12, 46080
    s_nop 0
    buffer_load_dwordx4 v3, s[40:43], s11 offen lds
    s_add_u32 m0, s12, 47104
    s_nop 0
    buffer_load_dwordx4 v4, s[40:43], s11 offen lds
    s_add_u32 m0, s13, 28672
    s_nop 0
    buffer_load_dwordx4 v1, s[44:47], s10 offen lds
    s_add_u32 m0, s13, 29696
    s_add_u32 s66, s10, 15360
    buffer_load_dwordx4 v1, s[44:47], s66 offen lds
    s_add_u32 m0, s13, 30720
    s_add_u32 s66, s10, 30720
    buffer_load_dwordx4 v5, s[44:47], s66 offen lds
    s_add_u32 m0, s13, 31744
    s_add_u32 s66, s10, 46080
    buffer_load_dwordx4 v5, s[44:47], s66 offen lds
    s_add_u32 s10, s10, 245760
    s_add_u32 s11, s11, 128
    s_cmp_eq_u32 s11, 1280
    s_cselect_b32 s10, 0, s10
    s_cselect_b32 s11, 0, s11
    s_mul_i32 s67, s71, 10240
    s_add_u32 s67, s67, 122880
    v_add_u32 v9, s67, v7
    v_add_u32 v10, 40960, v9
    s_lshl_b32 s14, s71, 10
    s_cmp_eq_u32 s6, 12
    s_cselect_b32 s66, 57344, 0
    s_sub_u32 s14, s14, s66
    s_mov_b32 s48, s38
    s_mov_b32 s49, s39
    s_mov_b32 s50, 20971520
    s_mov_b32 s51, 0x20000
    s_lshl_b32 s66, s4, 2
    s_add_u32 s66, s66, s71
    s_lshl_b32 s66, s66, 5
    s_add_u32 s66, s66, s5
    s_lshl_b32 s66, s66, 7
    s_add_u32 s66, s66, 15073280
    s_load_dword s100, s[38:39], s66
    s_waitcnt vmcnt(12)
    s_barrier
    s_add_u32 m0, s12, 73728
    s_nop 0
    buffer_load_dwordx4 v2, s[40:43], s11 offen lds
    s_add_u32 m0, s12, 74752
    s_nop 0
    buffer_load_dwordx4 v3, s[40:43], s11 offen lds
    s_add_u32 m0, s12, 75776
    s_nop 0
    buffer_load_dwordx4 v4, s[40:43], s11 offen lds
    s_add_u32 m0, s13, 57344
    s_nop 0
    buffer_load_dwordx4 v1, s[44:47], s10 offen lds
    s_add_u32 m0, s13, 58368
    s_add_u32 s66, s10, 15360
    buffer_load_dwordx4 v1, s[44:47], s66 offen lds
    s_add_u32 m0, s13, 59392
    s_add_u32 s66, s10, 30720
    buffer_load_dwordx4 v5, s[44:47], s66 offen lds
    s_add_u32 m0, s13, 60416
    s_add_u32 s66, s10, 46080
    buffer_load_dwordx4 v5, s[44:47], s66 offen lds
    s_add_u32 s10, s10, 245760
    s_add_u32 s11, s11, 128
    s_cmp_eq_u32 s11, 1280
    s_cselect_b32 s10, 0, s10
    s_cselect_b32 s11, 0, s11
    s_waitcnt vmcnt(7)
    s_barrier
    s_add_u32 m0, s12, 102400
    s_nop 0
    buffer_load_dwordx4 v2, s[40:43], s11 offen lds
    s_add_u32 m0, s12, 103424
    s_nop 0
    buffer_load_dwordx4 v3, s[40:43], s11 offen lds
    s_add_u32 m0, s12, 104448
    s_nop 0
    buffer_load_dwordx4 v4, s[40:43], s11 offen lds
    s_add_u32 m0, s13, 86016
    s_nop 0
    buffer_load_dwordx4 v1, s[44:47], s10 offen lds
    s_add_u32 m0, s13, 87040
    s_add_u32 s66, s10, 15360
    buffer_load_dwordx4 v1, s[44:47], s66 offen lds
    s_add_u32 m0, s13, 88064
    s_add_u32 s66, s10, 30720
    buffer_load_dwordx4 v5, s[44:47], s66 offen lds
    s_add_u32 m0, s13, 89088
    s_add_u32 s66, s10, 46080
    buffer_load_dwordx4 v5, s[44:47], s66 offen lds
    s_add_u32 s10, s10, 245760
    s_add_u32 s11, s11, 128
    s_cmp_eq_u32 s11, 1280
    s_cselect_b32 s10, 0, s10
    s_cselect_b32 s11, 0, s11
    s_waitcnt vmcnt(7)
    s_barrier
    s_add_u32 m0, s12, 16384
    s_nop 0
    buffer_load_dwordx4 v2, s[40:43], s11 offen lds
    s_add_u32 m0, s12, 17408
    s_nop 0
    buffer_load_dwordx4 v3, s[40:43], s11 offen lds
    s_add_u32 m0, s12, 18432
    s_nop 0
    buffer_load_dwordx4 v4, s[40:43], s11 offen lds
    s_add_u32 m0, s13, 0
    s_nop 0
    buffer_load_dwordx4 v1, s[44:47], s10 offen lds
    s_add_u32 m0, s13, 1024
    s_add_u32 s66, s10, 15360
    buffer_load_dwordx4 v1, s[44:47], s66 offen lds
    s_add_u32 m0, s13, 2048
    s_add_u32 s66, s10, 30720
    buffer_load_dwordx4 v5, s[44:47], s66 offen lds
    s_add_u32 m0, s13, 3072
    s_add_u32 s66, s10, 46080
    buffer_load_dwordx4 v5, s[44:47], s66 offen lds
    s_add_u32 s10, s10, 245760
    s_add_u32 s11, s11, 128
    s_cmp_eq_u32 s11, 1280
    s_cselect_b32 s10, 0, s10
    s_cselect_b32 s11, 0, s11
    s_waitcnt vmcnt(7)
    s_barrier
    s_add_u32 m0, s12, 45056
    s_nop 0
    buffer_load_dwordx4 v2, s[40:43], s11 offen lds
    s_add_u32 m0, s12, 46080
    s_nop 0
    buffer_load_dwordx4 v3, s[40:43], s11 offen lds
    s_add_u32 m0, s12, 47104
    s_nop 0
    buffer_load_dwordx4 v4, s[40:43], s11 offen lds
    s_add_u32 m0, s13, 28672
    s_nop 0
    buffer_load_dwordx4 v1, s[44:47], s10 offen lds
    s_add_u32 m0, s13, 29696
    s_add_u32 s66, s10, 15360
    buffer_load_dwordx4 v1, s[44:47], s66 offen lds
    s_add_u32 m0, s13, 30720
    s_add_u32 s66, s10, 30720
    buffer_load_dwordx4 v5, s[44:47], s66 offen lds
    s_add_u32 m0, s13, 31744
    s_add_u32 s66, s10, 46080
    buffer_load_dwordx4 v5, s[44:47], s66 offen lds
    s_add_u32 s10, s10, 245760
    s_add_u32 s11, s11, 128
    s_cmp_eq_u32 s11, 1280
    s_cselect_b32 s10, 0, s10
    s_cselect_b32 s11, 0, s11
    s_waitcnt vmcnt(7)
    s_barrier
    s_add_u32 m0, s12, 73728
    s_nop 0
    buffer_load_dwordx4 v2, s[40:43], s11 offen lds
    s_add_u32 m0, s12, 74752
    s_nop 0
    buffer_load_dwordx4 v3, s[40:43], s11 offen lds
    s_add_u32 m0, s12, 75776
    s_nop 0
    buffer_load_dwordx4 v4, s[40:43], s11 offen lds
    s_add_u32 m0, s13, 57344
    s_nop 0
    buffer_load_dwordx4 v1, s[44:47], s10 offen lds
    s_add_u32 m0, s13, 58368
    s_add_u32 s66, s10, 15360
    buffer_load_dwordx4 v1, s[44:47], s66 offen lds
    s_add_u32 m0, s13, 59392
    s_add_u32 s66, s10, 30720
    buffer_load_dwordx4 v5, s[44:47], s66 offen lds
    s_add_u32 m0, s13, 60416
    s_add_u32 s66, s10, 46080
    buffer_load_dwordx4 v5, s[44:47], s66 offen lds
    s_add_u32 s10, s10, 245760
    s_add_u32 s11, s11, 128
    s_cmp_eq_u32 s11, 1280
    s_cselect_b32 s10, 0, s10
    s_cselect_b32 s11, 0, s11
    s_waitcnt vmcnt(7)
    s_barrier
    s_add_u32 m0, s12, 102400
    s_nop 0
    buffer_load_dwordx4 v2, s[40:43], s11 offen lds
    s_add_u32 m0, s12, 103424
    s_nop 0
    buffer_load_dwordx4 v3, s[40:43], s11 offen lds
    s_add_u32 m0, s12, 104448
    s_nop 0
    buffer_load_dwordx4 v4, s[40:43], s11 offen lds
    s_add_u32 m0, s13, 86016
    s_nop 0
    buffer_load_dwordx4 v1, s[44:47], s10 offen lds
    s_add_u32 m0, s13, 87040
    s_add_u32 s66, s10, 15360
    buffer_load_dwordx4 v1, s[44:47], s66 offen lds
    s_add_u32 m0, s13, 88064
    s_add_u32 s66, s10, 30720
    buffer_load_dwordx4 v5, s[44:47], s66 offen lds
    s_add_u32 m0, s13, 89088
    s_add_u32 s66, s10, 46080
    buffer_load_dwordx4 v5, s[44:47], s66 offen lds
    s_add_u32 s10, s10, 245760
    s_add_u32 s11, s11, 128
    s_cmp_eq_u32 s11, 1280
    s_cselect_b32 s10, 0, s10
    s_cselect_b32 s11, 0, s11
    s_waitcnt vmcnt(7)
    s_barrier
    s_add_u32 m0, s12, 16384
    s_nop 0
    buffer_load_dwordx4 v2, s[40:43], s11 offen lds
    s_add_u32 m0, s12, 17408
    s_nop 0
    buffer_load_dwordx4 v3, s[40:43], s11 offen lds
    s_add_u32 m0, s12, 18432
    s_nop 0
    buffer_load_dwordx4 v4, s[40:43], s11 offen lds
    s_add_u32 m0, s13, 0
    s_nop 0
    buffer_load_dwordx4 v1, s[44:47], s10 offen lds
    s_add_u32 m0, s13, 1024
    s_add_u32 s66, s10, 15360
    buffer_load_dwordx4 v1, s[44:47], s66 offen lds
    s_add_u32 m0, s13, 2048
    s_add_u32 s66, s10, 30720
    buffer_load_dwordx4 v5, s[44:47], s66 offen lds
    s_add_u32 m0, s13, 3072
    s_add_u32 s66, s10, 46080
    buffer_load_dwordx4 v5, s[44:47], s66 offen lds
    s_add_u32 s10, s10, 245760
    s_add_u32 s11, s11, 128
    s_cmp_eq_u32 s11, 1280
    s_cselect_b32 s10, 0, s10
    s_cselect_b32 s11, 0, s11
    s_waitcnt vmcnt(7)
    s_barrier
    s_add_u32 m0, s12, 45056
    s_nop 0
    buffer_load_dwordx4 v2, s[40:43], s11 offen lds
    s_add_u32 m0, s12, 46080
    s_nop 0
    buffer_load_dwordx4 v3, s[40:43], s11 offen lds
    s_add_u32 m0, s12, 47104
    s_nop 0
    buffer_load_dwordx4 v4, s[40:43], s11 offen lds
    s_add_u32 m0, s13, 28672
    s_nop 0
    buffer_load_dwordx4 v1, s[44:47], s10 offen lds
    s_add_u32 m0, s13, 29696
    s_add_u32 s66, s10, 15360
    buffer_load_dwordx4 v1, s[44:47], s66 offen lds
    s_add_u32 m0, s13, 30720
    s_add_u32 s66, s10, 30720
    buffer_load_dwordx4 v5, s[44:47], s66 offen lds
    s_add_u32 m0, s13, 31744
    s_add_u32 s66, s10, 46080
    buffer_load_dwordx4 v5, s[44:47], s66 offen lds
    s_add_u32 s10, s10, 245760
    s_add_u32 s11, s11, 128
    s_cmp_eq_u32 s11, 1280
    s_cselect_b32 s10, 0, s10
    s_cselect_b32 s11, 0, s11
    s_load_dwordx2 s[64:65], s[36:37], 0
    s_waitcnt vmcnt(7)
    s_barrier
    s_add_u32 m0, s14, 114688
    s_nop 0
    buffer_load_dwordx4 v9, s[40:43], s11 offen lds
    s_add_u32 s11, s11, 128
    s_cmp_eq_u32 s11, 1280
    s_cselect_b32 s11, 0, s11
    s_add_u32 m0, s14, 118784
    s_nop 0
    buffer_load_dwordx4 v9, s[40:43], s11 offen lds
    s_add_u32 s11, s11, 128
    s_cmp_eq_u32 s11, 1280
    s_cselect_b32 s11, 0, s11
    s_add_u32 m0, s14, 122880
    s_nop 0
    buffer_load_dwordx4 v9, s[40:43], s11 offen lds
    s_add_u32 s11, s11, 128
    s_cmp_eq_u32 s11, 1280
    s_cselect_b32 s11, 0, s11
    s_add_u32 m0, s14, 126976
    s_nop 0
    buffer_load_dwordx4 v9, s[40:43], s11 offen lds
    s_add_u32 s11, s11, 128
    s_cmp_eq_u32 s11, 1280
    s_cselect_b32 s11, 0, s11
    s_add_u32 m0, s14, 131072
    s_nop 0
    buffer_load_dwordx4 v9, s[40:43], s11 offen lds
    s_add_u32 s11, s11, 128
    s_cmp_eq_u32 s11, 1280
    s_cselect_b32 s11, 0, s11
    s_add_u32 m0, s14, 135168
    s_nop 0
    buffer_load_dwordx4 v9, s[40:43], s11 offen lds
    s_add_u32 s11, s11, 128
    s_cmp_eq_u32 s11, 1280
    s_cselect_b32 s11, 0, s11
    s_add_u32 m0, s14, 139264
    s_nop 0
    buffer_load_dwordx4 v9, s[40:43], s11 offen lds
    s_add_u32 s11, s11, 128
    s_cmp_eq_u32 s11, 1280
    s_cselect_b32 s11, 0, s11
    s_waitcnt vmcnt(7)
    s_barrier
    s_add_u32 m0, s14, 143360
    s_nop 0
    buffer_load_dwordx4 v9, s[40:43], s11 offen lds
    s_add_u32 s11, s11, 128
    s_cmp_eq_u32 s11, 1280
    s_cselect_b32 s11, 0, s11
    s_add_u32 m0, s14, 147456
    s_nop 0
    buffer_load_dwordx4 v9, s[40:43], s11 offen lds
    s_add_u32 s11, s11, 128
    s_cmp_eq_u32 s11, 1280
    s_cselect_b32 s11, 0, s11
    s_add_u32 m0, s14, 151552
    s_nop 0
    buffer_load_dwordx4 v9, s[40:43], s11 offen lds
    s_add_u32 s11, s11, 128
    s_cmp_eq_u32 s11, 1280
    s_cselect_b32 s11, 0, s11
    s_cmp_eq_u32 s6, 12
    s_cbranch_scc1 .Lh_light
    s_add_u32 m0, s14, 57344
    s_nop 0
    buffer_load_dwordx4 v10, s[40:43], s11 offen lds
    s_add_u32 s11, s11, 128
    s_cmp_eq_u32 s11, 1280
    s_cselect_b32 s11, 0, s11
    s_add_u32 m0, s14, 61440
    s_nop 0
    buffer_load_dwordx4 v10, s[40:43], s11 offen lds
    s_add_u32 s11, s11, 128
    s_cmp_eq_u32 s11, 1280
    s_cselect_b32 s11, 0, s11
    s_add_u32 m0, s14, 65536
    s_nop 0
    buffer_load_dwordx4 v10, s[40:43], s11 offen lds
    s_add_u32 s11, s11, 128
    s_cmp_eq_u32 s11, 1280
    s_cselect_b32 s11, 0, s11
    s_add_u32 m0, s14, 69632
    s_nop 0
    buffer_load_dwordx4 v10, s[40:43], s11 offen lds
    s_add_u32 s11, s11, 128
    s_cmp_eq_u32 s11, 1280
    s_cselect_b32 s11, 0, s11
    s_waitcnt vmcnt(9)
    s_barrier
    s_add_u32 m0, s14, 73728
    s_nop 0
    buffer_load_dwordx4 v10, s[40:43], s11 offen lds
    s_add_u32 s11, s11, 128
    s_cmp_eq_u32 s11, 1280
    s_cselect_b32 s11, 0, s11
    s_add_u32 m0, s14, 77824
    s_nop 0
    buffer_load_dwordx4 v10, s[40:43], s11 offen lds
    s_add_u32 s11, s11, 128
    s_cmp_eq_u32 s11, 1280
    s_cselect_b32 s11, 0, s11
    s_add_u32 m0, s14, 81920
    s_nop 0
    buffer_load_dwordx4 v10, s[40:43], s11 offen lds
    s_add_u32 s11, s11, 128
    s_cmp_eq_u32 s11, 1280
    s_cselect_b32 s11, 0, s11
    s_add_u32 m0, s14, 86016
    s_nop 0
    buffer_load_dwordx4 v10, s[40:43], s11 offen lds
    s_add_u32 s11, s11, 128
    s_cmp_eq_u32 s11, 1280
    s_cselect_b32 s11, 0, s11
    s_add_u32 m0, s14, 90112
    s_nop 0
    buffer_load_dwordx4 v10, s[40:43], s11 offen lds
    s_add_u32 s11, s11, 128
    s_cmp_eq_u32 s11, 1280
    s_cselect_b32 s11, 0, s11
    s_add_u32 m0, s14, 94208
    s_nop 0
    buffer_load_dwordx4 v10, s[40:43], s11 offen lds
    s_add_u32 s11, s11, 128
    s_cmp_eq_u32 s11, 1280
    s_cselect_b32 s11, 0, s11
    s_waitcnt vmcnt(10)
    s_barrier
    s_branch .Lh_s3
.Lh_light:
    s_waitcnt vmcnt(5)
    s_barrier
.Lh_s3:
    s_waitcnt vmcnt(0)
    s_barrier
    s_setprio 3
    s_waitcnt lgkmcnt(0)
    s_cmp_lg_u32 s65, 0
    s_cbranch_scc1 .Ltagd_2
    v_mov_b32 v10, 0
    s_mov_b32 s74, 16384
.Ltag_1:
    global_load_dwordx2 v[8:9], v10, s[36:37] sc1
    s_waitcnt vmcnt(0)
    v_readfirstlane_b32 s64, v8
    v_readfirstlane_b32 s65, v9
    s_nop 0
    s_cmp_lg_u32 s65, 0
    s_cbranch_scc1 .Ltagd_2
    s_sub_u32 s74, s74, 1
    s_cbranch_scc0 .Ltag_1
.Ltagd_2:
    s_cmp_lg_u32 s71, 0
    s_cbranch_scc1 .Lh_np
    s_getreg_b32 s67, hwreg(HW_REG_XCC_ID)
    s_lshl_b32 s66, s4, 5
    s_add_u32 s66, s66, s5
    s_lshl_b32 s66, s66, 4
    s_add_u32 s66, s66, 14927360
    v_mov_b32 v8, s64
    v_mov_b32 v9, s65
    v_mov_b32 v10, s67
    v_mov_b32 v11, 0
    s_mov_b64 exec, 1
    buffer_store_dwordx4 v[8:11], v11, s[48:51], s66 offen sc1
    s_mov_b64 exec, -1
.Lh_np:
    s_cmp_eq_u32 s6, 12
    s_cselect_b32 s6, 0, 4
.Lunit:
    s_mov_b64 exec, 0x3fff
    buffer_load_dwordx2 v[8:9], v213, s[48:51], 0 offen sc1
    s_mov_b64 exec, -1
    v_mov_b32 v4, 0
    v_mov_b32 v5, 0
    v_mov_b32 v6, 0
    v_mov_b32 v7, 0
    s_lshl_b32 s66, s71, 9
    s_add_u32 s66, s66, 145152
    v_lshl_add_u32 v1, v0, 3, s66
    ds_write_b64 v1, v[4:5]
    s_cmp_lg_u32 s9, 0
    s_cbranch_scc1 .Lu_gather
    s_mul_i32 s66, s71, 8320
    s_add_u32 s66, s66, 111872
    v_add_u32 v1, s66, v15
    s_mov_b64 exec, 3
    ds_write_b128 v1, v[4:7]
    s_mov_b64 exec, -1
    ds_write_b128 v1, v[216:219] offset:32
    ds_write_b128 v1, v[220:223] offset:1056
    ds_write_b128 v1, v[224:227] offset:2080
    ds_write_b128 v1, v[228:231] offset:3104
    ds_read_b128 v[72:75], v1 offset:0
    ds_read_b32 v76, v1 offset:16
    ds_read_b128 v[80:83], v1 offset:1024
    ds_read_b32 v84, v1 offset:1040
    ds_read_b128 v[88:91], v1 offset:2048
    ds_read_b32 v92, v1 offset:2064
    ds_read_b128 v[96:99], v1 offset:3072
    ds_read_b32 v100, v1 offset:3088
    s_mov_b64 exec, 3
    ds_read_b128 v[104:107], v1 offset:4096
    ds_read_b32 v108, v1 offset:4112
    s_mov_b64 exec, -1
    s_waitcnt lgkmcnt(8)
    v_alignbit_b32 v72, v73, v72, 16
    v_alignbit_b32 v73, v74, v73, 16
    v_alignbit_b32 v74, v75, v74, 16
    v_alignbit_b32 v75, v76, v75, 16
    ds_write_b128 v1, v[72:75] offset:4160
    s_waitcnt lgkmcnt(7)
    v_alignbit_b32 v80, v81, v80, 16
    v_alignbit_b32 v81, v82, v81, 16
    v_alignbit_b32 v82, v83, v82, 16
    v_alignbit_b32 v83, v84, v83, 16
    ds_write_b128 v1, v[80:83] offset:5184
    s_waitcnt lgkmcnt(6)
    v_alignbit_b32 v88, v89, v88, 16
    v_alignbit_b32 v89, v90, v89, 16
    v_alignbit_b32 v90, v91, v90, 16
    v_alignbit_b32 v91, v92, v91, 16
    ds_write_b128 v1, v[88:91] offset:6208
    s_waitcnt lgkmcnt(5)
    v_alignbit_b32 v96, v97, v96, 16
    v_alignbit_b32 v97, v98, v97, 16
    v_alignbit_b32 v98, v99, v98, 16
    v_alignbit_b32 v99, v100, v99, 16
    ds_write_b128 v1, v[96:99] offset:7232
    s_waitcnt lgkmcnt(4)
    v_alignbit_b32 v104, v105, v104, 16
    v_alignbit_b32 v105, v106, v105, 16
    v_alignbit_b32 v106, v107, v106, 16
    v_alignbit_b32 v107, v108, v107, 16
    s_mov_b64 exec, 3
    ds_write_b128 v1, v[104:107] offset:8256
    s_mov_b64 exec, -1
.Lu_gather:
    s_waitcnt vmcnt(0)
    v_cmp_ne_u64 vcc, s[64:65], v[8:9]
    s_lshl_b32 s68, s71, 12
    s_and_b32 s66, vcc_lo, 0x3fff
    s_cbranch_scc0 .Lu_go
    s_mov_b32 s74, 16384
    s_mov_b64 exec, 0x3fff
.Lpoll_3:
    buffer_load_dwordx2 v[8:9], v213, s[48:51], 0 offen sc1
    s_waitcnt vmcnt(0)
    v_cmp_ne_u64 vcc, s[64:65], v[8:9]
    s_nop 0
    s_and_b64 exec, exec, vcc
    s_cbranch_scc0 .Lpolld_4
    s_sleep 3
    s_sub_u32 s74, s74, 1
    s_cbranch_scc0 .Lpoll_3
.Lpolld_4:
    s_mov_b64 exec, -1
.Lu_go:
    s_mov_b32 s67, 8388608
    s_add_u32 m0, s68, 147200
    s_nop 0
    buffer_load_dwordx4 v214, s[48:51], s67 offen sc1 lds
    s_add_u32 s67, s67, 165888
    s_add_u32 m0, s68, 148224
    s_nop 0
    buffer_load_dwordx4 v214, s[48:51], s67 offen sc1 lds
    s_add_u32 s67, s67, 165888
    s_add_u32 m0, s68, 149248
    s_nop 0
    buffer_load_dwordx4 v214, s[48:51], s67 offen sc1 lds
    s_add_u32 s67, s67, 165888
    s_add_u32 m0, s68, 150272
    s_nop 0
    buffer_load_dwordx4 v214, s[48:51], s67 offen sc1 lds
    s_and_b32 s7, s8, 3
    s_lshl_b32 s7, s7, 4
    v_xor_b32 v3, s7, v211
    v_and_or_b32 v209, v3, 48, v210
    s_bitcmp1_b32 s8, 0
    s_cselect_b32 s66, 16, 0
    s_lshr_b32 s70, s1, s66
    s_pack_ll_b32_b16 s70, s70, s70
    s_cmp_eq_u32 s9, 0
    s_cselect_b32 s70, s70, 0
    v_and_b32 v176, s70, v176
    v_and_b32 v177, s70, v177
    v_and_b32 v178, s70, v178
    v_and_b32 v179, s70, v179
    s_mov_b32 s52, s22
    s_mov_b32 s53, s23
    s_mov_b32 s54, 2621440
    s_mov_b32 s55, 0x20000
    s_lshl_b32 s13, s4, 2
    s_lshr_b32 s67, s5, 3
    s_add_u32 s13, s13, s67
    s_and_b32 s14, s5, 7
    s_mul_i32 s68, s14, 160
    s_mul_i32 s69, s13, 81920
    s_add_u32 s44, s69, s68
    s_add_u32 s45, s44, 5120
    s_add_u32 s15, s44, s69
    s_add_u32 s15, s15, 1280
    s_waitcnt vmcnt(0)
    v_mov_b32 v12, 163616
    v_mov_b32 v13, 1
    s_mov_b64 exec, 1
    ds_add_u32 v12, v13
    s_mov_b64 exec, -1
    v_mov_b32 v12, 163616
    s_mov_b32 s74, 65536
.Llw_5:
    ds_read_b32 v13, v12
    s_waitcnt lgkmcnt(0)
    v_readfirstlane_b32 s72, v13
    s_nop 0
    s_cmp_ge_u32 s72, 4
    s_cbranch_scc1 .Llwd_6
    s_sub_u32 s74, s74, 1
    s_cbranch_scc0 .Llw_5
.Llwd_6:
    s_cmp_eq_u32 s0, 4
    s_cbranch_scc1 .Lu_nq
    buffer_load_dwordx2 v[232:233], v192, s[52:55], s44 offen offset:0 nt
    buffer_load_dwordx2 v[234:235], v192, s[52:55], s44 offen offset:1280 nt
    buffer_load_dwordx2 v[236:237], v192, s[52:55], s44 offen offset:2560 nt
    buffer_load_dwordx2 v[238:239], v192, s[52:55], s44 offen offset:3840 nt
    buffer_load_dwordx2 v[240:241], v192, s[52:55], s45 offen offset:0 nt
    buffer_load_dwordx2 v[242:243], v192, s[52:55], s45 offen offset:1280 nt
    buffer_load_dwordx2 v[244:245], v192, s[52:55], s45 offen offset:2560 nt
    buffer_load_dwordx2 v[246:247], v192, s[52:55], s45 offen offset:3840 nt
.Lu_nq:
    s_setprio 0
    ds_read_b128 v[112:115], v209 offset:0
    ds_read2_b32 v[48:49], v205 offset0:0 offset1:1
    ds_read2_b32 v[50:51], v205 offset0:2 offset1:3
    ds_read_b128 v[116:119], v209 offset:2048
    ds_read2_b32 v[52:53], v205 offset0:128 offset1:129
    ds_read2_b32 v[54:55], v205 offset0:130 offset1:131
    ds_read_b128 v[120:123], v209 offset:4096
    ds_read2_b32 v[56:57], v206 offset0:0 offset1:1
    ds_read2_b32 v[58:59], v206 offset0:2 offset1:3
    ds_read_b128 v[124:127], v209 offset:6144
    ds_read2_b32 v[60:61], v206 offset0:128 offset1:129
    ds_read2_b32 v[62:63], v206 offset0:130 offset1:131
    s_waitcnt lgkmcnt(4)
    ds_read_b128 v[128:131], v209 offset:8192
    ds_read2_b32 v[64:65], v207 offset0:0 offset1:1
    ds_read2_b32 v[66:67], v207 offset0:2 offset1:3
    ds_read_b128 v[132:135], v209 offset:10240
    ds_read2_b32 v[68:69], v207 offset0:128 offset1:129
    ds_read2_b32 v[70:71], v207 offset0:130 offset1:131
    ds_read_b128 v[136:139], v209 offset:12288
    ds_read2_b32 v[72:73], v208 offset0:0 offset1:1
    ds_read2_b32 v[74:75], v208 offset0:2 offset1:3
    ds_read_b128 v[140:143], v209 offset:14336
    ds_read2_b32 v[76:77], v208 offset0:128 offset1:129
    ds_read2_b32 v[78:79], v208 offset0:130 offset1:131
    v_add_u32 v205, 64, v205
    v_add_u32 v206, 64, v206
    v_add_u32 v207, 64, v207
    v_add_u32 v208, 64, v208
    v_subrev_u32 v210, 256, v210
    v_subrev_u32 v211, 16, v211
    v_xor_b32 v3, s7, v211
    v_and_or_b32 v209, v3, 48, v210
    s_waitcnt lgkmcnt(0)
    v_mfma_f32_16x16x32_bf16 v[16:19], v[176:179], v[112:115], 0
    v_mfma_f32_16x16x32_bf16 v[20:23], v[176:179], v[116:119], 0
    v_mfma_f32_16x16x32_bf16 v[24:27], v[176:179], v[120:123], 0
    v_mfma_f32_16x16x32_bf16 v[28:31], v[176:179], v[124:127], 0
    v_mfma_f32_16x16x32_bf16 v[32:35], v[176:179], v[128:131], 0
    v_mfma_f32_16x16x32_bf16 v[36:39], v[176:179], v[132:135], 0
    v_mfma_f32_16x16x32_bf16 v[40:43], v[176:179], v[136:139], 0
    v_mfma_f32_16x16x32_bf16 v[44:47], v[176:179], v[140:143], 0
    s_lshr_b32 s66, s0, 1
.Lconv:
    buffer_load_dwordx2 v[10:11], v197, s[48:51], 0 offen sc1
    v_mfma_f32_16x16x32_bf16 v[16:19], v[48:51], v[112:115], v[16:19]
    ds_read_b128 v[144:147], v209 offset:0
    v_mfma_f32_16x16x32_bf16 v[20:23], v[48:51], v[116:119], v[20:23]
    ds_read2_b32 v[80:81], v205 offset0:0 offset1:1
    v_mfma_f32_16x16x32_bf16 v[24:27], v[48:51], v[120:123], v[24:27]
    ds_read2_b32 v[82:83], v205 offset0:2 offset1:3
    v_mfma_f32_16x16x32_bf16 v[28:31], v[48:51], v[124:127], v[28:31]
    ds_read_b128 v[148:151], v209 offset:2048
    v_mfma_f32_16x16x32_bf16 v[32:35], v[48:51], v[128:131], v[32:35]
    ds_read2_b32 v[84:85], v205 offset0:128 offset1:129
    v_mfma_f32_16x16x32_bf16 v[36:39], v[48:51], v[132:135], v[36:39]
    ds_read2_b32 v[86:87], v205 offset0:130 offset1:131
    v_mfma_f32_16x16x32_bf16 v[40:43], v[48:51], v[136:139], v[40:43]
    ds_read_b128 v[152:155], v209 offset:4096
    v_mfma_f32_16x16x32_bf16 v[44:47], v[48:51], v[140:143], v[44:47]
    ds_read2_b32 v[88:89], v206 offset0:0 offset1:1
    v_mfma_f32_16x16x32_bf16 v[20:23], v[52:55], v[112:115], v[20:23]
    ds_read2_b32 v[90:91], v206 offset0:2 offset1:3
    v_mfma_f32_16x16x32_bf16 v[24:27], v[52:55], v[116:119], v[24:27]
    ds_read_b128 v[156:159], v209 offset:6144
    v_mfma_f32_16x16x32_bf16 v[28:31], v[52:55], v[120:123], v[28:31]
    ds_read2_b32 v[92:93], v206 offset0:128 offset1:129
    v_mfma_f32_16x16x32_bf16 v[32:35], v[52:55], v[124:127], v[32:35]
    ds_read2_b32 v[94:95], v206 offset0:130 offset1:131
    v_mfma_f32_16x16x32_bf16 v[36:39], v[52:55], v[128:131], v[36:39]
    ds_read_b128 v[160:163], v209 offset:8192
    v_mfma_f32_16x16x32_bf16 v[40:43], v[52:55], v[132:135], v[40:43]
    ds_read2_b32 v[96:97], v207 offset0:0 offset1:1
    v_mfma_f32_16x16x32_bf16 v[44:47], v[52:55], v[136:139], v[44:47]
    ds_read2_b32 v[98:99], v207 offset0:2 offset1:3
    v_mfma_f32_16x16x32_bf16 v[24:27], v[56:59], v[112:115], v[24:27]
    ds_read_b128 v[164:167], v209 offset:10240
    v_mfma_f32_16x16x32_bf16 v[28:31], v[56:59], v[116:119], v[28:31]
    ds_read2_b32 v[100:101], v207 offset0:128 offset1:129
    v_mfma_f32_16x16x32_bf16 v[32:35], v[56:59], v[120:123], v[32:35]
    ds_read2_b32 v[102:103], v207 offset0:130 offset1:131
    v_mfma_f32_16x16x32_bf16 v[36:39], v[56:59], v[124:127], v[36:39]
    ds_read_b128 v[168:171], v209 offset:12288
    v_mfma_f32_16x16x32_bf16 v[40:43], v[56:59], v[128:131], v[40:43]
    ds_read2_b32 v[104:105], v208 offset0:0 offset1:1
    v_mfma_f32_16x16x32_bf16 v[44:47], v[56:59], v[132:135], v[44:47]
    ds_read2_b32 v[106:107], v208 offset0:2 offset1:3
    v_mfma_f32_16x16x32_bf16 v[28:31], v[60:63], v[112:115], v[28:31]
    ds_read_b128 v[172:175], v209 offset:14336
    v_mfma_f32_16x16x32_bf16 v[32:35], v[60:63], v[116:119], v[32:35]
    ds_read2_b32 v[108:109], v208 offset0:128 offset1:129
    v_mfma_f32_16x16x32_bf16 v[36:39], v[60:63], v[120:123], v[36:39]
    ds_read2_b32 v[110:111], v208 offset0:130 offset1:131
    v_mfma_f32_16x16x32_bf16 v[40:43], v[60:63], v[124:127], v[40:43]
    v_add_u32 v205, 64, v205
    v_mfma_f32_16x16x32_bf16 v[44:47], v[60:63], v[128:131], v[44:47]
    v_add_u32 v206, 64, v206
    v_mfma_f32_16x16x32_bf16 v[32:35], v[64:67], v[112:115], v[32:35]
    v_add_u32 v207, 64, v207
    v_mfma_f32_16x16x32_bf16 v[36:39], v[64:67], v[116:119], v[36:39]
    v_add_u32 v208, 64, v208
    v_mfma_f32_16x16x32_bf16 v[40:43], v[64:67], v[120:123], v[40:43]
    v_subrev_u32 v210, 256, v210
    v_mfma_f32_16x16x32_bf16 v[44:47], v[64:67], v[124:127], v[44:47]
    v_subrev_u32 v211, 16, v211
    v_mfma_f32_16x16x32_bf16 v[36:39], v[68:71], v[112:115], v[36:39]
    v_xor_b32 v3, s7, v211
    v_mfma_f32_16x16x32_bf16 v[40:43], v[68:71], v[116:119], v[40:43]
    v_and_or_b32 v209, v3, 48, v210
    v_mfma_f32_16x16x32_bf16 v[44:47], v[68:71], v[120:123], v[44:47]
    v_mfma_f32_16x16x32_bf16 v[40:43], v[72:75], v[112:115], v[40:43]
    v_mfma_f32_16x16x32_bf16 v[44:47], v[72:75], v[116:119], v[44:47]
    v_mfma_f32_16x16x32_bf16 v[44:47], v[76:79], v[112:115], v[44:47]
    s_waitcnt lgkmcnt(0)
    v_mfma_f32_16x16x32_bf16 v[16:19], v[80:83], v[144:147], v[16:19]
    ds_read_b128 v[112:115], v209 offset:0
    v_mfma_f32_16x16x32_bf16 v[20:23], v[80:83], v[148:151], v[20:23]
    ds_read2_b32 v[48:49], v205 offset0:0 offset1:1
    v_mfma_f32_16x16x32_bf16 v[24:27], v[80:83], v[152:155], v[24:27]
    ds_read2_b32 v[50:51], v205 offset0:2 offset1:3
    v_mfma_f32_16x16x32_bf16 v[28:31], v[80:83], v[156:159], v[28:31]
    ds_read_b128 v[116:119], v209 offset:2048
    v_mfma_f32_16x16x32_bf16 v[32:35], v[80:83], v[160:163], v[32:35]
    ds_read2_b32 v[52:53], v205 offset0:128 offset1:129
    v_mfma_f32_16x16x32_bf16 v[36:39], v[80:83], v[164:167], v[36:39]
    ds_read2_b32 v[54:55], v205 offset0:130 offset1:131
    v_mfma_f32_16x16x32_bf16 v[40:43], v[80:83], v[168:171], v[40:43]
    ds_read_b128 v[120:123], v209 offset:4096
    v_mfma_f32_16x16x32_bf16 v[44:47], v[80:83], v[172:175], v[44:47]
    ds_read2_b32 v[56:57], v206 offset0:0 offset1:1
    v_mfma_f32_16x16x32_bf16 v[20:23], v[84:87], v[144:147], v[20:23]
    ds_read2_b32 v[58:59], v206 offset0:2 offset1:3
    v_mfma_f32_16x16x32_bf16 v[24:27], v[84:87], v[148:151], v[24:27]
    ds_read_b128 v[124:127], v209 offset:6144
    v_mfma_f32_16x16x32_bf16 v[28:31], v[84:87], v[152:155], v[28:31]
    ds_read2_b32 v[60:61], v206 offset0:128 offset1:129
    v_mfma_f32_16x16x32_bf16 v[32:35], v[84:87], v[156:159], v[32:35]
    ds_read2_b32 v[62:63], v206 offset0:130 offset1:131
    v_mfma_f32_16x16x32_bf16 v[36:39], v[84:87], v[160:163], v[36:39]
    ds_read_b128 v[128:131], v209 offset:8192
    v_mfma_f32_16x16x32_bf16 v[40:43], v[84:87], v[164:167], v[40:43]
    ds_read2_b32 v[64:65], v207 offset0:0 offset1:1
    v_mfma_f32_16x16x32_bf16 v[44:47], v[84:87], v[168:171], v[44:47]
    ds_read2_b32 v[66:67], v207 offset0:2 offset1:3
    v_mfma_f32_16x16x32_bf16 v[24:27], v[88:91], v[144:147], v[24:27]
    ds_read_b128 v[132:135], v209 offset:10240
    v_mfma_f32_16x16x32_bf16 v[28:31], v[88:91], v[148:151], v[28:31]
    ds_read2_b32 v[68:69], v207 offset0:128 offset1:129
    v_mfma_f32_16x16x32_bf16 v[32:35], v[88:91], v[152:155], v[32:35]
    ds_read2_b32 v[70:71], v207 offset0:130 offset1:131
    v_mfma_f32_16x16x32_bf16 v[36:39], v[88:91], v[156:159], v[36:39]
    ds_read_b128 v[136:139], v209 offset:12288
    v_mfma_f32_16x16x32_bf16 v[40:43], v[88:91], v[160:163], v[40:43]
    ds_read2_b32 v[72:73], v208 offset0:0 offset1:1
    v_mfma_f32_16x16x32_bf16 v[44:47], v[88:91], v[164:167], v[44:47]
    ds_read2_b32 v[74:75], v208 offset0:2 offset1:3
    v_mfma_f32_16x16x32_bf16 v[28:31], v[92:95], v[144:147], v[28:31]
    ds_read_b128 v[140:143], v209 offset:14336
    v_mfma_f32_16x16x32_bf16 v[32:35], v[92:95], v[148:151], v[32:35]
    ds_read2_b32 v[76:77], v208 offset0:128 offset1:129
    v_mfma_f32_16x16x32_bf16 v[36:39], v[92:95], v[152:155], v[36:39]
    ds_read2_b32 v[78:79], v208 offset0:130 offset1:131
    v_mfma_f32_16x16x32_bf16 v[40:43], v[92:95], v[156:159], v[40:43]
    v_add_u32 v205, 64, v205
    v_mfma_f32_16x16x32_bf16 v[44:47], v[92:95], v[160:163], v[44:47]
    v_add_u32 v206, 64, v206
    v_mfma_f32_16x16x32_bf16 v[32:35], v[96:99], v[144:147], v[32:35]
    v_add_u32 v207, 64, v207
    v_mfma_f32_16x16x32_bf16 v[36:39], v[96:99], v[148:151], v[36:39]
    v_add_u32 v208, 64, v208
    v_mfma_f32_16x16x32_bf16 v[40:43], v[96:99], v[152:155], v[40:43]
    v_subrev_u32 v210, 256, v210
    v_mfma_f32_16x16x32_bf16 v[44:47], v[96:99], v[156:159], v[44:47]
    v_subrev_u32 v211, 16, v211
    v_mfma_f32_16x16x32_bf16 v[36:39], v[100:103], v[144:147], v[36:39]
    v_xor_b32 v3, s7, v211
    v_mfma_f32_16x16x32_bf16 v[40:43], v[100:103], v[148:151], v[40:43]
    v_and_or_b32 v209, v3, 48, v210
    v_mfma_f32_16x16x32_bf16 v[44:47], v[100:103], v[152:155], v[44:47]
    v_mfma_f32_16x16x32_bf16 v[40:43], v[104:107], v[144:147], v[40:43]
    v_mfma_f32_16x16x32_bf16 v[44:47], v[104:107], v[148:151], v[44:47]
    v_mfma_f32_16x16x32_bf16 v[44:47], v[108:111], v[144:147], v[44:47]
    s_waitcnt lgkmcnt(0)
    s_sub_u32 s66, s66, 1
    s_cmp_lg_u32 s66, 0
    s_cbranch_scc1 .Lconv
    s_setprio 3
    s_waitcnt vmcnt(0)
    v_cmp_ne_u64 s[46:47], s[64:65], v[10:11]
    s_lshl_b32 s12, s8, 12
    s_lshl_b32 s68, s9, 10
    s_add_u32 s12, s12, s68
    s_add_u32 s12, s12, 11534336
    s_cmp_eq_u32 s0, 4
    s_cbranch_scc1 .Lu_two
    v_mov_b32 v12, 163600
    v_mov_b32 v13, 1
    s_mov_b64 exec, 1
    ds_add_u32 v12, v13
    s_mov_b64 exec, -1
    v_cvt_pk_bf16_f32 v72, v32, v33
    v_cvt_pk_bf16_f32 v73, v34, v35
    v_cvt_pk_bf16_f32 v74, v36, v37
    v_cvt_pk_bf16_f32 v75, v38, v39
    v_cvt_pk_bf16_f32 v76, v40, v41
    v_cvt_pk_bf16_f32 v77, v42, v43
    v_cvt_pk_bf16_f32 v78, v44, v45
    v_cvt_pk_bf16_f32 v79, v46, v47
    v_permlane16_swap_b32 v72, v74
    v_permlane16_swap_b32 v73, v75
    buffer_store_dwordx4 v[72:75], v212, s[48:51], s12 offen offset:2048 sc1
    v_permlane16_swap_b32 v76, v78
    v_permlane16_swap_b32 v77, v79
    buffer_store_dwordx4 v[76:79], v212, s[48:51], s12 offen offset:3072 sc1
    s_branch .Lu_out
.Lu_two:
    s_lshl_b32 s66, s71, 12
    s_add_u32 s66, s66, 128512
    v_add_u32 v1, s66, v15
    s_cmp_lg_u32 s9, 0
    s_mov_b32 s67, 8192
    s_cbranch_scc0 .Lu_lo
    s_mov_b32 s67, -8192
    v_swap_b32 v16, v32
    v_swap_b32 v17, v33
    v_swap_b32 v18, v34
    v_swap_b32 v19, v35
    v_swap_b32 v20, v36
    v_swap_b32 v21, v37
    v_swap_b32 v22, v38
    v_swap_b32 v23, v39
    v_swap_b32 v24, v40
    v_swap_b32 v25, v41
    v_swap_b32 v26, v42
    v_swap_b32 v27, v43
    v_swap_b32 v28, v44
    v_swap_b32 v29, v45
    v_swap_b32 v30, v46
    v_swap_b32 v31, v47
.Lu_lo:
    v_add_u32 v2, s67, v1
    ds_write_b128 v1, v[32:35] offset:0
    ds_write_b128 v1, v[36:39] offset:1024
    ds_write_b128 v1, v[40:43] offset:2048
    ds_write_b128 v1, v[44:47] offset:3072
    s_and_b32 s66, s71, 1
    s_lshl_b32 s66, s66, 2
    s_add_u32 s66, s66, 163624
    v_mov_b32 v12, s66
    v_mov_b32 v13, 1
    s_mov_b64 exec, 1
    ds_add_u32 v12, v13
    s_mov_b64 exec, -1
    v_mov_b32 v12, s66
    s_mov_b32 s74, 65536
.Llw_7:
    ds_read_b32 v13, v12
    s_waitcnt lgkmcnt(0)
    v_readfirstlane_b32 s72, v13
    s_nop 0
    s_cmp_ge_u32 s72, 2
    s_cbranch_scc1 .Llwd_8
    s_sub_u32 s74, s74, 1
    s_cbranch_scc0 .Llw_7
.Llwd_8:
    ds_read_b128 v[48:51], v2 offset:0
    ds_read_b128 v[52:55], v2 offset:1024
    ds_read_b128 v[56:59], v2 offset:2048
    ds_read_b128 v[60:63], v2 offset:3072
    s_waitcnt lgkmcnt(3)
    v_add_f32 v16, v16, v48
    v_add_f32 v17, v17, v49
    v_add_f32 v18, v18, v50
    v_add_f32 v19, v19, v51
    s_waitcnt lgkmcnt(2)
    v_add_f32 v20, v20, v52
    v_add_f32 v21, v21, v53
    v_add_f32 v22, v22, v54
    v_add_f32 v23, v23, v55
    s_waitcnt lgkmcnt(1)
    v_add_f32 v24, v24, v56
    v_add_f32 v25, v25, v57
    v_add_f32 v26, v26, v58
    v_add_f32 v27, v27, v59
    s_waitcnt lgkmcnt(0)
    v_add_f32 v28, v28, v60
    v_add_f32 v29, v29, v61
    v_add_f32 v30, v30, v62
    v_add_f32 v31, v31, v63
    v_mov_b32 v12, 163600
    v_mov_b32 v13, 1
    s_mov_b64 exec, 1
    ds_add_u32 v12, v13
    s_mov_b64 exec, -1
.Lu_out:
    v_cvt_pk_bf16_f32 v64, v16, v17
    v_cvt_pk_bf16_f32 v65, v18, v19
    v_cvt_pk_bf16_f32 v66, v20, v21
    v_cvt_pk_bf16_f32 v67, v22, v23
    v_cvt_pk_bf16_f32 v68, v24, v25
    v_cvt_pk_bf16_f32 v69, v26, v27
    v_cvt_pk_bf16_f32 v70, v28, v29
    v_cvt_pk_bf16_f32 v71, v30, v31
    v_permlane16_swap_b32 v64, v66
    v_permlane16_swap_b32 v65, v67
    buffer_store_dwordx4 v[64:67], v212, s[48:51], s12 offen offset:0 sc1
    v_permlane16_swap_b32 v68, v70
    v_permlane16_swap_b32 v69, v71
    buffer_store_dwordx4 v[68:71], v212, s[48:51], s12 offen offset:1024 sc1
    s_mov_b32 s56, s34
    s_mov_b32 s57, s35
    s_mov_b32 s58, 5242880
    s_mov_b32 s59, 0x20000
    s_lshr_b32 s68, s5, 3
    s_and_b32 s67, s5, 1
    s_add_u32 s68, s68, s67
    s_lshl_b32 s68, s68, 2
    s_cmp_eq_u32 s0, 8
    s_cselect_b32 s6, 1, 3
    s_cselect_b32 s7, 2, 0
    s_add_u32 s12, s68, s71
    s_and_b32 s7, s7, s71
    s_lshl_b32 s7, s7, 1
    s_add_u32 s7, s7, 163640
    s_lshr_b32 s8, s8, 1
    s_cmp_eq_u64 s[46:47], 0
    s_cbranch_scc0 .Lh_wp
.Lh_wpd:
    v_mov_b32 v8, 163600
    s_mov_b32 s74, 65536
.Llw_9:
    ds_read_b32 v9, v8
    s_waitcnt lgkmcnt(0)
    v_readfirstlane_b32 s72, v9
    s_nop 0
    s_cmp_ge_u32 s72, 4
    s_cbranch_scc1 .Llwd_10
    s_sleep 1
    s_sub_u32 s74, s74, 1
    s_cbranch_scc0 .Llw_9
.Llwd_10:
    v_mov_b32 v8, 163584
    s_mov_b32 s74, 65536
.Llw_11:
    ds_read_b32 v9, v8
    s_waitcnt lgkmcnt(0)
    v_readfirstlane_b32 s72, v9
    s_nop 0
    s_cmp_ge_u32 s72, 4
    s_cbranch_scc1 .Llwd_12
    s_sleep 1
    s_sub_u32 s74, s74, 1
    s_cbranch_scc0 .Llw_11
.Llwd_12:
    s_and_b32 s10, s5, 7
    s_mul_i32 s10, s10, 102400
    s_add_u32 s10, s10, 15728640
    s_mul_i32 s11, s12, 5120
    s_add_u32 s67, s10, s11
    s_add_u32 m0, s11, 49664
    s_nop 0
    buffer_load_dwordx4 v15, s[48:51], s67 offen offset:0 sc1 lds
    buffer_load_dwordx4 v15, s[48:51], s67 offen offset:1024 sc1 lds
    buffer_load_dwordx4 v15, s[48:51], s67 offen offset:2048 sc1 lds
    buffer_load_dwordx4 v15, s[48:51], s67 offen offset:3072 sc1 lds
    s_add_u32 s67, s67, 4096
    s_add_u32 m0, s11, 53760
    s_nop 0
    buffer_load_dwordx4 v15, s[48:51], s67 offen sc1 lds
    s_waitcnt vmcnt(5)
    v_mov_b32 v8, s7
    v_mov_b32 v9, 1
    s_mov_b64 exec, 1
    ds_add_rtn_u32 v9, v8, v9
    s_waitcnt lgkmcnt(0)
    v_readfirstlane_b32 s66, v9
    s_mov_b64 exec, -1
    s_cmp_lg_u32 s66, s6
    s_cbranch_scc1 .Lwf_13
    s_lshl_b32 s66, s8, 7
    s_add_u32 s66, s66, 14886400
    v_mov_b32 v8, s64
    v_mov_b32 v9, s65
    v_mov_b32 v10, 0
    v_mov_b32 v11, 0
    v_lshlrev_b32 v12, 4, v0
    s_mov_b64 exec, 0xff
    buffer_store_dwordx4 v[8:11], v12, s[48:51], s66 offen sc1
    s_mov_b64 exec, -1
.Lwf_13:
    s_cmp_eq_u32 s0, 8
    s_cbranch_scc1 .Lh_nq
    buffer_load_dwordx2 v[232:233], v192, s[52:55], s44 offen offset:0 nt
    buffer_load_dwordx2 v[234:235], v192, s[52:55], s44 offen offset:1280 nt
    buffer_load_dwordx2 v[236:237], v192, s[52:55], s44 offen offset:2560 nt
    buffer_load_dwordx2 v[238:239], v192, s[52:55], s44 offen offset:3840 nt
    buffer_load_dwordx2 v[240:241], v192, s[52:55], s45 offen offset:0 nt
    buffer_load_dwordx2 v[242:243], v192, s[52:55], s45 offen offset:1280 nt
    buffer_load_dwordx2 v[244:245], v192, s[52:55], s45 offen offset:2560 nt
    buffer_load_dwordx2 v[246:247], v192, s[52:55], s45 offen offset:3840 nt
.Lh_nq:
    s_add_u32 s11, s11, 20480
    s_cmp_ge_u32 s11, 102400
    s_cselect_b32 s67, 102400, 0
    s_sub_u32 s11, s11, s67
    s_add_u32 s67, s10, s11
    s_add_u32 m0, s11, 49664
    s_nop 0
    buffer_load_dwordx4 v15, s[48:51], s67 offen offset:0 sc1 lds
    buffer_load_dwordx4 v15, s[48:51], s67 offen offset:1024 sc1 lds
    buffer_load_dwordx4 v15, s[48:51], s67 offen offset:2048 sc1 lds
    buffer_load_dwordx4 v15, s[48:51], s67 offen offset:3072 sc1 lds
    s_add_u32 s67, s67, 4096
    s_add_u32 m0, s11, 53760
    s_nop 0
    buffer_load_dwordx4 v15, s[48:51], s67 offen sc1 lds
    s_add_u32 s11, s11, 20480
    s_cmp_ge_u32 s11, 102400
    s_cselect_b32 s67, 102400, 0
    s_sub_u32 s11, s11, s67
    s_add_u32 s67, s10, s11
    s_add_u32 m0, s11, 49664
    s_nop 0
    buffer_load_dwordx4 v15, s[48:51], s67 offen offset:0 sc1 lds
    buffer_load_dwordx4 v15, s[48:51], s67 offen offset:1024 sc1 lds
    buffer_load_dwordx4 v15, s[48:51], s67 offen offset:2048 sc1 lds
    buffer_load_dwordx4 v15, s[48:51], s67 offen offset:3072 sc1 lds
    s_add_u32 s67, s67, 4096
    s_add_u32 m0, s11, 53760
    s_nop 0
    buffer_load_dwordx4 v15, s[48:51], s67 offen sc1 lds
    s_add_u32 s11, s11, 20480
    s_cmp_ge_u32 s11, 102400
    s_cselect_b32 s67, 102400, 0
    s_sub_u32 s11, s11, s67
    s_add_u32 s67, s10, s11
    s_add_u32 m0, s11, 49664
    s_nop 0
    buffer_load_dwordx4 v15, s[48:51], s67 offen offset:0 sc1 lds
    buffer_load_dwordx4 v15, s[48:51], s67 offen offset:1024 sc1 lds
    buffer_load_dwordx4 v15, s[48:51], s67 offen offset:2048 sc1 lds
    buffer_load_dwordx4 v15, s[48:51], s67 offen offset:3072 sc1 lds
    s_add_u32 s67, s67, 4096
    s_add_u32 m0, s11, 53760
    s_nop 0
    buffer_load_dwordx4 v15, s[48:51], s67 offen sc1 lds
    s_add_u32 s11, s11, 20480
    s_cmp_ge_u32 s11, 102400
    s_cselect_b32 s67, 102400, 0
    s_sub_u32 s11, s11, s67
    s_add_u32 s67, s10, s11
    s_add_u32 m0, s11, 49664
    s_nop 0
    buffer_load_dwordx4 v15, s[48:51], s67 offen offset:0 sc1 lds
    buffer_load_dwordx4 v15, s[48:51], s67 offen offset:1024 sc1 lds
    buffer_load_dwordx4 v15, s[48:51], s67 offen offset:2048 sc1 lds
    buffer_load_dwordx4 v15, s[48:51], s67 offen offset:3072 sc1 lds
    s_add_u32 s67, s67, 4096
    s_add_u32 m0, s11, 53760
    s_nop 0
    buffer_load_dwordx4 v15, s[48:51], s67 offen sc1 lds
    s_waitcnt vmcnt(0)
    v_mov_b32 v8, 163588
    v_mov_b32 v9, 1
    s_mov_b64 exec, 1
    ds_add_u32 v8, v9
    s_mov_b64 exec, -1
    s_mov_b32 s74, 16384
    s_mov_b64 exec, 0x3ff
.Lpoll_14:
    buffer_load_dwordx2 v[8:9], v194, s[48:51], 0 offen sc1
    s_waitcnt vmcnt(0)
    v_cmp_ne_u64 vcc, s[64:65], v[8:9]
    s_nop 0
    s_and_b64 exec, exec, vcc
    s_cbranch_scc0 .Lpolld_15
    s_sleep 4
    s_sub_u32 s74, s74, 1
    s_cbranch_scc0 .Lpoll_14
.Lpolld_15:
    s_mov_b64 exec, -1
    s_mul_i32 s66, s14, 327680
    s_lshl_b32 s67, s13, 7
    s_add_u32 s66, s66, s67
    s_add_u32 s66, s66, 11534336
    s_mul_i32 s67, s71, 2560
    s_add_u32 m0, s67, 152064
    s_nop 0
    buffer_load_dwordx4 v189, s[48:51], s66 offen sc1 lds
    s_add_u32 m0, s67, 153088
    s_nop 0
    buffer_load_dwordx4 v190, s[48:51], s66 offen sc1 lds
    s_add_u32 m0, s67, 154112
    s_mov_b32 exec_hi, 0
    buffer_load_dwordx4 v191, s[48:51], s66 offen sc1 lds
    s_mov_b64 exec, -1
    s_waitcnt vmcnt(0)
    v_mov_b32 v8, 163596
    v_mov_b32 v9, 1
    s_mov_b64 exec, 1
    ds_add_u32 v8, v9
    s_mov_b64 exec, -1
    v_mov_b32 v8, 163596
    s_mov_b32 s74, 65536
.Llw_16:
    ds_read_b32 v9, v8
    s_waitcnt lgkmcnt(0)
    v_readfirstlane_b32 s72, v9
    s_nop 0
    s_cmp_ge_u32 s72, 4
    s_cbranch_scc1 .Llwd_17
    s_sleep 1
    s_sub_u32 s74, s74, 1
    s_cbranch_scc0 .Llw_16
.Llwd_17:
    s_setprio 0
    ds_read_b128 v[40:43], v193 offset:0
    ds_read_b128 v[44:47], v193 offset:128
    ds_read_b128 v[48:51], v193 offset:256
    ds_read_b128 v[52:55], v193 offset:384
    s_waitcnt lgkmcnt(0)
    v_lshlrev_b32 v96, 16, v232
    v_lshlrev_b32 v100, 16, v40
    v_and_b32 v97, v196, v232
    v_lshlrev_b32 v101, 16, v44
    v_lshlrev_b32 v98, 16, v233
    v_lshlrev_b32 v102, 16, v48
    v_and_b32 v99, v196, v233
    v_lshlrev_b32 v103, 16, v52
    v_mul_f32 v96, v96, v100
    v_mul_f32 v97, v97, v101
    v_mul_f32 v98, v98, v102
    v_mul_f32 v99, v99, v103
    v_cvt_pk_bf16_f32 v232, v96, v97
    v_cvt_pk_bf16_f32 v233, v98, v99
    buffer_store_dwordx2 v[232:233], v195, s[56:59], s15 offen offset:0 nt
    v_lshlrev_b32 v104, 16, v234
    v_and_b32 v108, v196, v40
    v_and_b32 v105, v196, v234
    v_and_b32 v109, v196, v44
    v_lshlrev_b32 v106, 16, v235
    v_and_b32 v110, v196, v48
    v_and_b32 v107, v196, v235
    v_and_b32 v111, v196, v52
    v_mul_f32 v104, v104, v108
    v_mul_f32 v105, v105, v109
    v_mul_f32 v106, v106, v110
    v_mul_f32 v107, v107, v111
    v_cvt_pk_bf16_f32 v234, v104, v105
    v_cvt_pk_bf16_f32 v235, v106, v107
    buffer_store_dwordx2 v[234:235], v195, s[56:59], s15 offen offset:2560 nt
    s_add_u32 s15, s15, 5120
    v_lshlrev_b32 v96, 16, v236
    v_lshlrev_b32 v100, 16, v41
    v_and_b32 v97, v196, v236
    v_lshlrev_b32 v101, 16, v45
    v_lshlrev_b32 v98, 16, v237
    v_lshlrev_b32 v102, 16, v49
    v_and_b32 v99, v196, v237
    v_lshlrev_b32 v103, 16, v53
    v_mul_f32 v96, v96, v100
    v_mul_f32 v97, v97, v101
    v_mul_f32 v98, v98, v102
    v_mul_f32 v99, v99, v103
    v_cvt_pk_bf16_f32 v236, v96, v97
    v_cvt_pk_bf16_f32 v237, v98, v99
    buffer_store_dwordx2 v[236:237], v195, s[56:59], s15 offen offset:0 nt
    v_lshlrev_b32 v104, 16, v238
    v_and_b32 v108, v196, v41
    v_and_b32 v105, v196, v238
    v_and_b32 v109, v196, v45
    v_lshlrev_b32 v106, 16, v239
    v_and_b32 v110, v196, v49
    v_and_b32 v107, v196, v239
    v_and_b32 v111, v196, v53
    v_mul_f32 v104, v104, v108
    v_mul_f32 v105, v105, v109
    v_mul_f32 v106, v106, v110
    v_mul_f32 v107, v107, v111
    v_cvt_pk_bf16_f32 v238, v104, v105
    v_cvt_pk_bf16_f32 v239, v106, v107
    buffer_store_dwordx2 v[238:239], v195, s[56:59], s15 offen offset:2560 nt
    s_add_u32 s15, s15, 5120
    v_lshlrev_b32 v96, 16, v240
    v_lshlrev_b32 v100, 16, v42
    v_and_b32 v97, v196, v240
    v_lshlrev_b32 v101, 16, v46
    v_lshlrev_b32 v98, 16, v241
    v_lshlrev_b32 v102, 16, v50
    v_and_b32 v99, v196, v241
    v_lshlrev_b32 v103, 16, v54
    v_mul_f32 v96, v96, v100
    v_mul_f32 v97, v97, v101
    v_mul_f32 v98, v98, v102
    v_mul_f32 v99, v99, v103
    v_cvt_pk_bf16_f32 v240, v96, v97
    v_cvt_pk_bf16_f32 v241, v98, v99
    buffer_store_dwordx2 v[240:241], v195, s[56:59], s15 offen offset:0 nt
    v_lshlrev_b32 v104, 16, v242
    v_and_b32 v108, v196, v42
    v_and_b32 v105, v196, v242
    v_and_b32 v109, v196, v46
    v_lshlrev_b32 v106, 16, v243
    v_and_b32 v110, v196, v50
    v_and_b32 v107, v196, v243
    v_and_b32 v111, v196, v54
    v_mul_f32 v104, v104, v108
    v_mul_f32 v105, v105, v109
    v_mul_f32 v106, v106, v110
    v_mul_f32 v107, v107, v111
    v_cvt_pk_bf16_f32 v242, v104, v105
    v_cvt_pk_bf16_f32 v243, v106, v107
    buffer_store_dwordx2 v[242:243], v195, s[56:59], s15 offen offset:2560 nt
    s_add_u32 s15, s15, 5120
    v_lshlrev_b32 v96, 16, v244
    v_lshlrev_b32 v100, 16, v43
    v_and_b32 v97, v196, v244
    v_lshlrev_b32 v101, 16, v47
    v_lshlrev_b32 v98, 16, v245
    v_lshlrev_b32 v102, 16, v51
    v_and_b32 v99, v196, v245
    v_lshlrev_b32 v103, 16, v55
    v_mul_f32 v96, v96, v100
    v_mul_f32 v97, v97, v101
    v_mul_f32 v98, v98, v102
    v_mul_f32 v99, v99, v103
    v_cvt_pk_bf16_f32 v244, v96, v97
    v_cvt_pk_bf16_f32 v245, v98, v99
    buffer_store_dwordx2 v[244:245], v195, s[56:59], s15 offen offset:0 nt
    v_lshlrev_b32 v104, 16, v246
    v_and_b32 v108, v196, v43
    v_and_b32 v105, v196, v246
    v_and_b32 v109, v196, v47
    v_lshlrev_b32 v106, 16, v247
    v_and_b32 v110, v196, v51
    v_and_b32 v107, v196, v247
    v_and_b32 v111, v196, v55
    v_mul_f32 v104, v104, v108
    v_mul_f32 v105, v105, v109
    v_mul_f32 v106, v106, v110
    v_mul_f32 v107, v107, v111
    v_cvt_pk_bf16_f32 v246, v104, v105
    v_cvt_pk_bf16_f32 v247, v106, v107
    buffer_store_dwordx2 v[246:247], v195, s[56:59], s15 offen offset:2560 nt
    s_add_u32 s15, s15, 5120
    s_endpgm
.Lh_wp:
    s_mov_b32 s74, 16384
    s_mov_b64 exec, 0x1f
.Lpoll_18:
    buffer_load_dwordx2 v[8:9], v197, s[48:51], 0 offen sc1
    s_waitcnt vmcnt(0)
    v_cmp_ne_u64 vcc, s[64:65], v[8:9]
    s_nop 0
    s_and_b64 exec, exec, vcc
    s_cbranch_scc0 .Lpolld_19
    s_sleep 2
    s_sub_u32 s74, s74, 1
    s_cbranch_scc0 .Lpoll_18
.Lpolld_19:
    s_mov_b64 exec, -1
    s_branch .Lh_wpd
.Lmap3:
    s_mul_i32 s66, s67, 20
    s_add_u32 s66, s66, s5
    s_add_u32 s68, s5, s67
    s_cmp_ge_u32 s68, 28
    s_cselect_b32 s69, 4, 8
    s_cselect_b32 s6, 24, 16
    s_mul_i32 s69, s69, s67
    s_add_u32 s6, s6, s69
    s_add_u32 s6, s6, s68
    s_cmp_ge_u32 s68, 20
    s_cbranch_scc1 .Lfree
    s_add_u32 s8, s66, 272
    s_mul_i32 s6, s66, 86
    s_lshr_b32 s6, s6, 8
    s_mul_i32 s68, s6, 3
    s_sub_u32 s7, s66, s68
    s_add_u32 s7, s7, 12
    s_branch .Lmapd
.Lfree_a:
    s_lshl_b32 s6, s68, 1
    s_add_u32 s6, s6, s67
    s_mul_i32 s6, s6, 6
    s_add_u32 s6, s6, s5
    s_sub_u32 s6, s6, 26
.Lfree:
    s_lshl_b32 s8, s6, 1
    s_cmp_ge_u32 s6, 52
    s_cbranch_scc1 .Ltouch
    s_mul_i32 s67, s6, 51200
    s_lshl_b32 s10, s3, 10
    s_add_u32 s67, s67, s10
    v_lshl_add_u32 v2, v0, 4, s67
    v_subrev_u32 v1, 3840, v2
    v_lshlrev_b32 v3, 4, v0
    s_waitcnt lgkmcnt(0)
    s_mov_b32 s52, s24
    s_mov_b32 s53, s25
    s_mov_b32 s54, 2621440
    s_mov_b32 s55, 0x20000
    s_mov_b32 s56, s26
    s_mov_b32 s57, s27
    s_mov_b32 s58, 2621440
    s_mov_b32 s59, 0x20000
    s_mov_b32 s60, s28
    s_mov_b32 s61, s29
    s_mov_b32 s62, 5120
    s_mov_b32 s63, 0x20000
    s_add_u32 m0, s10, 0
    s_nop 0
    buffer_load_dwordx4 v1, s[52:55], 0 offen nt lds
    s_add_u32 m0, s10, 55296
    s_nop 0
    buffer_load_dwordx4 v2, s[56:59], 0 offen nt lds
    s_mov_b32 s66, 4352
    s_add_u32 m0, s10, 8192
    s_nop 0
    buffer_load_dwordx4 v2, s[52:55], s66 offen nt lds
    s_mov_b32 s66, 8192
    s_add_u32 m0, s10, 63488
    s_nop 0
    buffer_load_dwordx4 v2, s[56:59], s66 offen nt lds
    s_mov_b32 s48, s38
    s_mov_b32 s49, s39
    s_mov_b32 s50, 20971520
    s_mov_b32 s51, 0x20000
    v_mov_b32 v9, 0
    v_lshlrev_b32 v8, 2, v0
    v_add_u32 v8, 163584, v8
    ds_write_b32 v8, v9
    v_bfe_u32 v5, v0, 2, 2
    v_mul_u32_u24 v5, 1280, v5
    v_lshrrev_b32 v6, 4, v0
    v_lshl_add_u32 v5, v6, 5, v5
    v_and_b32 v6, 3, v0
    v_lshl_add_u32 v5, v6, 3, v5
    v_lshlrev_b32 v4, 3, v0
    v_mov_b32 v14, 0xffff0000
    s_mul_i32 s11, s6, 51840
    s_add_u32 s11, s11, s10
    s_lshl_b32 s12, s3, 7
    s_mov_b32 s13, s3
    s_lshl_b32 s68, s13, 9
    buffer_load_dwordx2 v[96:97], v4, s[60:63], s68 offen
    v_add_u32 v112, s12, v5
    s_add_u32 s40, s11, 8388608
    s_cmp_ge_u32 s13, 2
    s_cselect_b32 s66, 8960, 0
    s_cselect_b32 s67, -2, 8
    s_cselect_b32 s68, 128, 0
    s_add_u32 s11, s11, s68
    s_add_u32 s12, s12, s66
    s_add_u32 s12, s12, 1024
    s_add_u32 s13, s13, s67
    s_lshl_b32 s68, s13, 9
    buffer_load_dwordx2 v[98:99], v4, s[60:63], s68 offen
    v_add_u32 v113, s12, v5
    s_add_u32 s41, s11, 8396800
    s_cmp_ge_u32 s13, 2
    s_cselect_b32 s66, 8960, 0
    s_cselect_b32 s67, -2, 8
    s_cselect_b32 s68, 128, 0
    s_add_u32 s11, s11, s68
    s_add_u32 s12, s12, s66
    s_add_u32 s12, s12, 1024
    s_add_u32 s13, s13, s67
    s_lshl_b32 s68, s13, 9
    buffer_load_dwordx2 v[100:101], v4, s[60:63], s68 offen
    v_add_u32 v114, s12, v5
    s_add_u32 s42, s11, 8404992
    s_cmp_ge_u32 s13, 2
    s_cselect_b32 s66, 8960, 0
    s_cselect_b32 s67, -2, 8
    s_cselect_b32 s68, 128, 0
    s_add_u32 s11, s11, s68
    s_add_u32 s12, s12, s66
    s_add_u32 s12, s12, 1024
    s_add_u32 s13, s13, s67
    s_lshl_b32 s68, s13, 9
    buffer_load_dwordx2 v[102:103], v4, s[60:63], s68 offen
    v_add_u32 v115, s12, v5
    s_add_u32 s43, s11, 8413184
    s_cmp_ge_u32 s13, 2
    s_cselect_b32 s66, 8960, 0
    s_cselect_b32 s67, -2, 8
    s_cselect_b32 s68, 128, 0
    s_add_u32 s11, s11, s68
    s_add_u32 s12, s12, s66
    s_add_u32 s12, s12, 1024
    s_add_u32 s13, s13, s67
    s_lshl_b32 s68, s13, 9
    buffer_load_dwordx2 v[104:105], v4, s[60:63], s68 offen
    v_add_u32 v116, s12, v5
    s_add_u32 s44, s11, 8421376
    s_cmp_ge_u32 s13, 2
    s_cselect_b32 s66, 8960, 0
    s_cselect_b32 s67, -2, 8
    s_cselect_b32 s68, 128, 0
    s_add_u32 s11, s11, s68
    s_add_u32 s12, s12, s66
    s_add_u32 s12, s12, 1024
    s_add_u32 s13, s13, s67
    s_lshl_b32 s68, s13, 9
    v_add_u32 v117, s12, v5
    s_add_u32 s45, s11, 8429568
    s_cmp_ge_u32 s13, 2
    s_cselect_b32 s66, 8960, 0
    s_cselect_b32 s67, -2, 8
    s_cselect_b32 s68, 128, 0
    s_add_u32 s11, s11, s68
    s_add_u32 s12, s12, s66
    s_add_u32 s12, s12, 1024
    s_add_u32 s13, s13, s67
    s_lshl_b32 s68, s13, 9
    v_add_u32 v118, s12, v5
    s_add_u32 s46, s11, 8437760
    s_cmp_ge_u32 s13, 2
    s_cselect_b32 s66, 8960, 0
    s_cselect_b32 s67, -2, 8
    s_cselect_b32 s68, 128, 0
    s_add_u32 s11, s11, s68
    s_add_u32 s12, s12, s66
    s_add_u32 s12, s12, 1024
    s_add_u32 s13, s13, s67
    s_and_b32 s71, s3, 3
    s_mov_b32 s0, 8
    s_lshl_b32 s8, s8, 1
    s_and_b32 s9, s71, 2
    s_cmp_eq_u32 s0, 8
    s_cselect_b32 s9, 0, s9
    s_add_u32 s8, s8, s71
    s_sub_u32 s8, s8, s9
    s_and_b32 s66, s5, 7
    s_mul_i32 s66, s66, 20
    s_add_u32 s66, s66, s71
    s_lshl_b32 s66, s66, 7
    s_add_u32 s66, s66, 14931456
    v_min_u32 v197, 4, v0
    v_lshl_add_u32 v197, v197, 9, s66
    v_and_b32 v200, 15, v0
    v_lshrrev_b32 v201, 4, v0
    v_lshl_add_u32 v211, v200, 1, v201
    s_lshl_b32 s66, s9, 3
    s_sub_u32 s66, 30, s66
    v_add_u32 v211, s66, v211
    v_lshlrev_b32 v210, 6, v211
    v_add_u32 v210, 145152, v210
    v_lshlrev_b32 v211, 2, v211
    v_lshlrev_b32 v202, 3, v201
    v_sub_u32 v202, v200, v202
    v_add_u32 v202, 25, v202
    v_and_b32 v203, 1, v202
    v_mul_u32_u24 v203, 4160, v203
    v_lshrrev_b32 v202, 1, v202
    v_lshl_add_u32 v202, v202, 2, v203
    s_sub_u32 s67, s71, s9
    s_mul_i32 s67, s67, 8320
    s_lshl_b32 s66, s9, 7
    s_add_u32 s66, s66, s67
    s_add_u32 s66, s66, 111872
    v_add_u32 v205, s66, v202
    v_add_u32 v206, 1024, v205
    v_add_u32 v207, 2048, v205
    v_add_u32 v208, 3072, v205
    v_and_b32 v202, 7, v200
    v_sub_u32 v202, 7, v202
    v_and_b32 v203, 1, v202
    v_lshlrev_b32 v203, 4, v203
    v_mov_b32 v204, 0xffff
    v_lshlrev_b32 v203, v203, v204
    v_lshrrev_b32 v204, 3, v200
    v_add_u32 v204, 2, v204
    v_cmp_eq_u32 vcc, v204, v201
    v_lshrrev_b32 v202, 1, v202
    s_nop 0
    v_cndmask_b32 v203, 0, v203, vcc
    v_cmp_eq_u32 vcc, 0, v202
    s_nop 1
    v_cndmask_b32 v176, 0, v203, vcc
    v_cmp_eq_u32 vcc, 1, v202
    s_nop 1
    v_cndmask_b32 v177, 0, v203, vcc
    v_cmp_eq_u32 vcc, 2, v202
    s_nop 1
    v_cndmask_b32 v178, 0, v203, vcc
    v_cmp_eq_u32 vcc, 3, v202
    s_nop 1
    v_cndmask_b32 v179, 0, v203, vcc
    v_and_b32 v212, 1, v201
    v_lshlrev_b32 v212, 9, v212
    v_lshrrev_b32 v202, 1, v201
    v_lshl_add_u32 v212, v202, 6, v212
    v_lshrrev_b32 v202, 2, v200
    v_lshl_add_u32 v212, v202, 7, v212
    v_and_b32 v202, 3, v200
    v_lshl_add_u32 v212, v202, 4, v212
    s_mul_i32 s66, s71, 13
    s_sub_u32 s66, s66, 1
    s_max_i32 s66, s66, 0
    s_lshl_b32 s66, s66, 7
    s_add_u32 s66, s66, 14879744
    v_lshl_add_u32 v213, v0, 7, s66
    v_lshrrev_b32 v202, 2, v0
    v_mul_u32_u24 v202, 10368, v202
    v_xor_b32 v203, v201, v0
    v_and_b32 v203, 3, v203
    v_lshl_add_u32 v202, v203, 4, v202
    s_mul_i32 s66, s71, 663552
    s_lshr_b32 s67, s8, 2
    s_lshl_b32 s67, s67, 6
    s_add_u32 s66, s66, s67
    v_add_u32 v214, s66, v202
    v_cmp_lt_u32 vcc, 19, v0
    s_nop 1
    v_cndmask_b32 v192, 0, 1, vcc
    v_mul_u32_u24 v201, 20, v192
    v_sub_u32 v201, v0, v201
    s_lshl_b32 s67, s71, 4
    v_lshl_add_u32 v202, v192, 6, s67
    v_and_b32 v203, 7, v201
    v_lshlrev_b32 v203, 4, v203
    v_xor_b32 v202, v202, v203
    v_lshl_add_u32 v202, v201, 9, v202
    v_add_u32 v193, 152064, v202
    s_lshl_b32 s67, s71, 1
    v_add_u32 v192, s67, v192
    v_mul_u32_u24 v192, 10240, v192
    v_lshlrev_b32 v201, 3, v201
    v_mov_b32 v203, 1073741824
    v_cmp_gt_u32 vcc, 40, v0
    s_nop 1
    v_cndmask_b32 v201, v203, v201, vcc
    v_lshl_add_u32 v195, v192, 1, v201
    v_add_u32 v192, v192, v201
    s_mul_i32 s67, s71, 20
    v_lshrrev_b32 v201, 3, v0
    s_add_u32 s68, s67, 0
    v_add_u32 v202, s68, v201
    v_lshrrev_b32 v203, 2, v202
    v_xor_b32 v203, v203, v0
    v_and_b32 v203, 7, v203
    v_lshlrev_b32 v202, 12, v202
    v_lshl_add_u32 v189, v203, 4, v202
    s_add_u32 s68, s67, 8
    v_add_u32 v202, s68, v201
    v_lshrrev_b32 v203, 2, v202
    v_xor_b32 v203, v203, v0
    v_and_b32 v203, 7, v203
    v_lshlrev_b32 v202, 12, v202
    v_lshl_add_u32 v190, v203, 4, v202
    s_add_u32 s68, s67, 16
    v_add_u32 v202, s68, v201
    v_lshrrev_b32 v203, 2, v202
    v_xor_b32 v203, v203, v0
    v_and_b32 v203, 7, v203
    v_lshlrev_b32 v202, 12, v202
    v_lshl_add_u32 v191, v203, 4, v202
    s_and_b32 s66, s5, 7
    s_mul_i32 s66, s66, 40
    s_mul_i32 s67, s71, 10
    s_add_u32 s66, s66, s67
    s_lshl_b32 s66, s66, 7
    s_add_u32 s66, s66, 14886400
    v_lshl_add_u32 v194, v0, 7, s66
    v_mov_b32 v196, 0xffff0000
    s_waitcnt lgkmcnt(0)
    s_barrier
    s_mov_b32 s66, 12544
    s_add_u32 m0, s10, 16384
    s_nop 0
    buffer_load_dwordx4 v2, s[52:55], s66 offen nt lds
    s_mov_b32 s66, 16384
    s_add_u32 m0, s10, 71680
    s_nop 0
    buffer_load_dwordx4 v2, s[56:59], s66 offen nt lds
    s_barrier
    s_mov_b32 s66, 20736
    s_add_u32 m0, s10, 24576
    s_nop 0
    buffer_load_dwordx4 v2, s[52:55], s66 offen nt lds
    s_mov_b32 s66, 24576
    s_add_u32 m0, s10, 79872
    s_nop 0
    buffer_load_dwordx4 v2, s[56:59], s66 offen nt lds
    s_waitcnt vmcnt(4)
    s_barrier
    ds_read_b64_tr_b16 v[40:41], v112 offset:0
    ds_read_b64_tr_b16 v[42:43], v112 offset:5120
    ds_read_b64_tr_b16 v[44:45], v112 offset:10240
    ds_read_b64_tr_b16 v[46:47], v112 offset:55296
    ds_read_b64_tr_b16 v[48:49], v112 offset:60416
    s_mov_b32 s66, 28928
    s_add_u32 m0, s10, 32768
    s_nop 0
    buffer_load_dwordx4 v2, s[52:55], s66 offen nt lds
    s_mov_b32 s66, 32768
    s_add_u32 m0, s10, 88064
    s_nop 0
    buffer_load_dwordx4 v2, s[56:59], s66 offen nt lds
    v_alignbit_b32 v96, v96, v96, 16
    v_alignbit_b32 v97, v97, v97, 16
    v_alignbit_b32 v98, v98, v98, 16
    v_alignbit_b32 v99, v99, v99, 16
    v_alignbit_b32 v100, v100, v100, 16
    v_alignbit_b32 v101, v101, v101, 16
    v_alignbit_b32 v102, v102, v102, 16
    v_alignbit_b32 v103, v103, v103, 16
    v_alignbit_b32 v104, v104, v104, 16
    v_alignbit_b32 v105, v105, v105, 16
    s_waitcnt lgkmcnt(0)
    v_alignbit_b32 v16, v41, v40, 16
    v_alignbit_b32 v17, v42, v41, 16
    v_alignbit_b32 v18, v43, v42, 16
    v_alignbit_b32 v19, v44, v43, 16
    v_alignbit_b32 v20, v45, v44, 16
    v_dot2_f32_bf16 v32, v40, v97, 0
    v_dot2_f32_bf16 v33, v16, v97, 0
    v_dot2_f32_bf16 v34, v41, v97, 0
    v_dot2_f32_bf16 v35, v17, v97, 0
    v_dot2_f32_bf16 v36, v42, v97, 0
    v_dot2_f32_bf16 v37, v18, v97, 0
    v_dot2_f32_bf16 v38, v43, v97, 0
    v_dot2_f32_bf16 v39, v19, v97, 0
    v_dot2_f32_bf16 v32, v41, v96, v32
    v_dot2_f32_bf16 v33, v17, v96, v33
    v_dot2_f32_bf16 v34, v42, v96, v34
    v_dot2_f32_bf16 v35, v18, v96, v35
    v_dot2_f32_bf16 v36, v43, v96, v36
    v_dot2_f32_bf16 v37, v19, v96, v37
    v_dot2_f32_bf16 v38, v44, v96, v38
    v_dot2_f32_bf16 v39, v20, v96, v39
    v_lshlrev_b32 v24, 16, v46
    v_and_b32 v25, v14, v46
    v_lshlrev_b32 v26, 16, v47
    v_and_b32 v27, v14, v47
    v_lshlrev_b32 v28, 16, v48
    v_and_b32 v29, v14, v48
    v_lshlrev_b32 v30, 16, v49
    v_and_b32 v31, v14, v49
    v_mul_f32 v32, v32, v24
    v_mul_f32 v33, v33, v25
    v_mul_f32 v34, v34, v26
    v_mul_f32 v35, v35, v27
    v_mul_f32 v36, v36, v28
    v_mul_f32 v37, v37, v29
    v_mul_f32 v38, v38, v30
    v_mul_f32 v39, v39, v31
    v_cvt_pk_bf16_f32 v64, v39, v38
    v_cvt_pk_bf16_f32 v65, v37, v36
    v_cvt_pk_bf16_f32 v66, v35, v34
    v_cvt_pk_bf16_f32 v67, v33, v32
    s_waitcnt vmcnt(4)
    s_barrier
    ds_read_b64_tr_b16 v[50:51], v113 offset:0
    ds_read_b64_tr_b16 v[52:53], v113 offset:5120
    ds_read_b64_tr_b16 v[54:55], v113 offset:10240
    ds_read_b64_tr_b16 v[56:57], v113 offset:55296
    ds_read_b64_tr_b16 v[58:59], v113 offset:60416
    s_mov_b32 s66, 37120
    s_add_u32 m0, s10, 40960
    s_nop 0
    buffer_load_dwordx4 v2, s[52:55], s66 offen nt lds
    s_mov_b32 s66, 40960
    s_add_u32 m0, s10, 96256
    s_nop 0
    buffer_load_dwordx4 v2, s[56:59], s66 offen nt lds
    s_mov_b32 s66, 45312
    s_add_u32 m0, s10, 49152
    s_cmp_lt_u32 s3, 6
    s_cselect_b32 s66, s66, 1073741824
    s_cselect_b32 m0, m0, 112640
    s_nop 0
    buffer_load_dwordx4 v2, s[52:55], s66 offen nt lds
    s_mov_b32 s66, 49152
    s_add_u32 m0, s10, 104448
    s_cmp_lt_u32 s3, 2
    s_cselect_b32 s66, s66, 1073741824
    s_cselect_b32 m0, m0, 112640
    s_nop 0
    buffer_load_dwordx4 v2, s[56:59], s66 offen nt lds
    s_waitcnt lgkmcnt(0)
    v_alignbit_b32 v16, v51, v50, 16
    v_alignbit_b32 v17, v52, v51, 16
    v_alignbit_b32 v18, v53, v52, 16
    v_alignbit_b32 v19, v54, v53, 16
    v_alignbit_b32 v20, v55, v54, 16
    v_dot2_f32_bf16 v32, v50, v99, 0
    v_dot2_f32_bf16 v33, v16, v99, 0
    v_dot2_f32_bf16 v34, v51, v99, 0
    v_dot2_f32_bf16 v35, v17, v99, 0
    v_dot2_f32_bf16 v36, v52, v99, 0
    v_dot2_f32_bf16 v37, v18, v99, 0
    v_dot2_f32_bf16 v38, v53, v99, 0
    v_dot2_f32_bf16 v39, v19, v99, 0
    v_dot2_f32_bf16 v32, v51, v98, v32
    v_dot2_f32_bf16 v33, v17, v98, v33
    v_dot2_f32_bf16 v34, v52, v98, v34
    v_dot2_f32_bf16 v35, v18, v98, v35
    v_dot2_f32_bf16 v36, v53, v98, v36
    v_dot2_f32_bf16 v37, v19, v98, v37
    v_dot2_f32_bf16 v38, v54, v98, v38
    v_dot2_f32_bf16 v39, v20, v98, v39
    v_lshlrev_b32 v24, 16, v56
    v_and_b32 v25, v14, v56
    v_lshlrev_b32 v26, 16, v57
    v_and_b32 v27, v14, v57
    v_lshlrev_b32 v28, 16, v58
    v_and_b32 v29, v14, v58
    v_lshlrev_b32 v30, 16, v59
    v_and_b32 v31, v14, v59
    v_mul_f32 v32, v32, v24
    v_mul_f32 v33, v33, v25
    v_mul_f32 v34, v34, v26
    v_mul_f32 v35, v35, v27
    v_mul_f32 v36, v36, v28
    v_mul_f32 v37, v37, v29
    v_mul_f32 v38, v38, v30
    v_mul_f32 v39, v39, v31
    v_cvt_pk_bf16_f32 v68, v39, v38
    v_cvt_pk_bf16_f32 v69, v37, v36
    v_cvt_pk_bf16_f32 v70, v35, v34
    v_cvt_pk_bf16_f32 v71, v33, v32
    s_mov_b32 s60, s30
    s_mov_b32 s61, s31
    s_mov_b32 s62, 2621440
    s_mov_b32 s63, 0x20000
    s_lshl_b32 s66, s8, 12
    s_cmp_eq_u32 s9, 0
    s_cselect_b32 s66, s66, 1073741824
    s_cmp_ge_u32 s3, 4
    s_cselect_b32 s66, s66, 1073741824
    v_lshlrev_b32 v15, 4, v0
    buffer_load_dwordx4 v[216:219], v15, s[60:63], s66 offen offset:0 nt
    buffer_load_dwordx4 v[220:223], v15, s[60:63], s66 offen offset:1024 nt
    buffer_load_dwordx4 v[224:227], v15, s[60:63], s66 offen offset:2048 nt
    buffer_load_dwordx4 v[228:231], v15, s[60:63], s66 offen offset:3072 nt
    s_lshr_b32 s67, s8, 1
    s_lshl_b32 s67, s67, 2
    s_load_dword s1, s[32:33], s67
    s_load_dwordx2 s[64:65], s[36:37], 0
    s_waitcnt vmcnt(8)
    s_barrier
    ds_read_b64_tr_b16 v[40:41], v114 offset:0
    ds_read_b64_tr_b16 v[42:43], v114 offset:5120
    ds_read_b64_tr_b16 v[44:45], v114 offset:10240
    ds_read_b64_tr_b16 v[46:47], v114 offset:55296
    ds_read_b64_tr_b16 v[48:49], v114 offset:60416
    s_waitcnt lgkmcnt(0)
    v_alignbit_b32 v16, v41, v40, 16
    v_alignbit_b32 v17, v42, v41, 16
    v_alignbit_b32 v18, v43, v42, 16
    v_alignbit_b32 v19, v44, v43, 16
    v_alignbit_b32 v20, v45, v44, 16
    v_dot2_f32_bf16 v32, v40, v101, 0
    v_dot2_f32_bf16 v33, v16, v101, 0
    v_dot2_f32_bf16 v34, v41, v101, 0
    v_dot2_f32_bf16 v35, v17, v101, 0
    v_dot2_f32_bf16 v36, v42, v101, 0
    v_dot2_f32_bf16 v37, v18, v101, 0
    v_dot2_f32_bf16 v38, v43, v101, 0
    v_dot2_f32_bf16 v39, v19, v101, 0
    v_dot2_f32_bf16 v32, v41, v100, v32
    v_dot2_f32_bf16 v33, v17, v100, v33
    v_dot2_f32_bf16 v34, v42, v100, v34
    v_dot2_f32_bf16 v35, v18, v100, v35
    v_dot2_f32_bf16 v36, v43, v100, v36
    v_dot2_f32_bf16 v37, v19, v100, v37
    v_dot2_f32_bf16 v38, v44, v100, v38
    v_dot2_f32_bf16 v39, v20, v100, v39
    v_lshlrev_b32 v24, 16, v46
    v_and_b32 v25, v14, v46
    v_lshlrev_b32 v26, 16, v47
    v_and_b32 v27, v14, v47
    v_lshlrev_b32 v28, 16, v48
    v_and_b32 v29, v14, v48
    v_lshlrev_b32 v30, 16, v49
    v_and_b32 v31, v14, v49
    v_mul_f32 v32, v32, v24
    v_mul_f32 v33, v33, v25
    v_mul_f32 v34, v34, v26
    v_mul_f32 v35, v35, v27
    v_mul_f32 v36, v36, v28
    v_mul_f32 v37, v37, v29
    v_mul_f32 v38, v38, v30
    v_mul_f32 v39, v39, v31
    v_cvt_pk_bf16_f32 v72, v39, v38
    v_cvt_pk_bf16_f32 v73, v37, v36
    v_cvt_pk_bf16_f32 v74, v35, v34
    v_cvt_pk_bf16_f32 v75, v33, v32
    s_waitcnt vmcnt(6)
    s_barrier
    ds_read_b64_tr_b16 v[50:51], v115 offset:0
    ds_read_b64_tr_b16 v[52:53], v115 offset:5120
    ds_read_b64_tr_b16 v[54:55], v115 offset:10240
    ds_read_b64_tr_b16 v[56:57], v115 offset:55296
    ds_read_b64_tr_b16 v[58:59], v115 offset:60416
    ds_read_b64_tr_b16 v[40:41], v116 offset:0
    ds_read_b64_tr_b16 v[42:43], v116 offset:5120
    ds_read_b64_tr_b16 v[44:45], v116 offset:10240
    ds_read_b64_tr_b16 v[46:47], v116 offset:55296
    ds_read_b64_tr_b16 v[48:49], v116 offset:60416
    s_waitcnt lgkmcnt(5)
    v_alignbit_b32 v16, v51, v50, 16
    v_alignbit_b32 v17, v52, v51, 16
    v_alignbit_b32 v18, v53, v52, 16
    v_alignbit_b32 v19, v54, v53, 16
    v_alignbit_b32 v20, v55, v54, 16
    v_dot2_f32_bf16 v32, v50, v103, 0
    v_dot2_f32_bf16 v33, v16, v103, 0
    v_dot2_f32_bf16 v34, v51, v103, 0
    v_dot2_f32_bf16 v35, v17, v103, 0
    v_dot2_f32_bf16 v36, v52, v103, 0
    v_dot2_f32_bf16 v37, v18, v103, 0
    v_dot2_f32_bf16 v38, v53, v103, 0
    v_dot2_f32_bf16 v39, v19, v103, 0
    v_dot2_f32_bf16 v32, v51, v102, v32
    v_dot2_f32_bf16 v33, v17, v102, v33
    v_dot2_f32_bf16 v34, v52, v102, v34
    v_dot2_f32_bf16 v35, v18, v102, v35
    v_dot2_f32_bf16 v36, v53, v102, v36
    v_dot2_f32_bf16 v37, v19, v102, v37
    v_dot2_f32_bf16 v38, v54, v102, v38
    v_dot2_f32_bf16 v39, v20, v102, v39
    v_lshlrev_b32 v24, 16, v56
    v_and_b32 v25, v14, v56
    v_lshlrev_b32 v26, 16, v57
    v_and_b32 v27, v14, v57
    v_lshlrev_b32 v28, 16, v58
    v_and_b32 v29, v14, v58
    v_lshlrev_b32 v30, 16, v59
    v_and_b32 v31, v14, v59
    v_mul_f32 v32, v32, v24
    v_mul_f32 v33, v33, v25
    v_mul_f32 v34, v34, v26
    v_mul_f32 v35, v35, v27
    v_mul_f32 v36, v36, v28
    v_mul_f32 v37, v37, v29
    v_mul_f32 v38, v38, v30
    v_mul_f32 v39, v39, v31
    v_cvt_pk_bf16_f32 v76, v39, v38
    v_cvt_pk_bf16_f32 v77, v37, v36
    v_cvt_pk_bf16_f32 v78, v35, v34
    v_cvt_pk_bf16_f32 v79, v33, v32
    buffer_store_dwordx4 v[64:67], v3, s[48:51], s40 offen sc1
    buffer_store_dwordx4 v[68:71], v3, s[48:51], s41 offen sc1
    buffer_store_dwordx4 v[72:75], v3, s[48:51], s42 offen sc1
    buffer_store_dwordx4 v[76:79], v3, s[48:51], s43 offen sc1
    s_waitcnt vmcnt(8)
    s_barrier
    ds_read_b64_tr_b16 v[50:51], v117 offset:0
    ds_read_b64_tr_b16 v[52:53], v117 offset:5120
    ds_read_b64_tr_b16 v[54:55], v117 offset:10240
    ds_read_b64_tr_b16 v[56:57], v117 offset:55296
    ds_read_b64_tr_b16 v[58:59], v117 offset:60416
    s_waitcnt lgkmcnt(5)
    v_alignbit_b32 v16, v41, v40, 16
    v_alignbit_b32 v17, v42, v41, 16
    v_alignbit_b32 v18, v43, v42, 16
    v_alignbit_b32 v19, v44, v43, 16
    v_alignbit_b32 v20, v45, v44, 16
    v_dot2_f32_bf16 v32, v40, v105, 0
    v_dot2_f32_bf16 v33, v16, v105, 0
    v_dot2_f32_bf16 v34, v41, v105, 0
    v_dot2_f32_bf16 v35, v17, v105, 0
    v_dot2_f32_bf16 v36, v42, v105, 0
    v_dot2_f32_bf16 v37, v18, v105, 0
    v_dot2_f32_bf16 v38, v43, v105, 0
    v_dot2_f32_bf16 v39, v19, v105, 0
    v_dot2_f32_bf16 v32, v41, v104, v32
    v_dot2_f32_bf16 v33, v17, v104, v33
    v_dot2_f32_bf16 v34, v42, v104, v34
    v_dot2_f32_bf16 v35, v18, v104, v35
    v_dot2_f32_bf16 v36, v43, v104, v36
    v_dot2_f32_bf16 v37, v19, v104, v37
    v_dot2_f32_bf16 v38, v44, v104, v38
    v_dot2_f32_bf16 v39, v20, v104, v39
    v_lshlrev_b32 v24, 16, v46
    v_and_b32 v25, v14, v46
    v_lshlrev_b32 v26, 16, v47
    v_and_b32 v27, v14, v47
    v_lshlrev_b32 v28, 16, v48
    v_and_b32 v29, v14, v48
    v_lshlrev_b32 v30, 16, v49
    v_and_b32 v31, v14, v49
    v_mul_f32 v32, v32, v24
    v_mul_f32 v33, v33, v25
    v_mul_f32 v34, v34, v26
    v_mul_f32 v35, v35, v27
    v_mul_f32 v36, v36, v28
    v_mul_f32 v37, v37, v29
    v_mul_f32 v38, v38, v30
    v_mul_f32 v39, v39, v31
    v_cvt_pk_bf16_f32 v80, v39, v38
    v_cvt_pk_bf16_f32 v81, v37, v36
    v_cvt_pk_bf16_f32 v82, v35, v34
    v_cvt_pk_bf16_f32 v83, v33, v32
    buffer_store_dwordx4 v[80:83], v3, s[48:51], s44 offen sc1
    ds_read_b64_tr_b16 v[40:41], v118 offset:0
    ds_read_b64_tr_b16 v[42:43], v118 offset:5120
    ds_read_b64_tr_b16 v[44:45], v118 offset:10240
    ds_read_b64_tr_b16 v[46:47], v118 offset:55296
    ds_read_b64_tr_b16 v[48:49], v118 offset:60416
    s_waitcnt lgkmcnt(5)
    v_alignbit_b32 v16, v51, v50, 16
    v_alignbit_b32 v17, v52, v51, 16
    v_alignbit_b32 v18, v53, v52, 16
    v_alignbit_b32 v19, v54, v53, 16
    v_alignbit_b32 v20, v55, v54, 16
    v_dot2_f32_bf16 v32, v50, v97, 0
    v_dot2_f32_bf16 v33, v16, v97, 0
    v_dot2_f32_bf16 v34, v51, v97, 0
    v_dot2_f32_bf16 v35, v17, v97, 0
    v_dot2_f32_bf16 v36, v52, v97, 0
    v_dot2_f32_bf16 v37, v18, v97, 0
    v_dot2_f32_bf16 v38, v53, v97, 0
    v_dot2_f32_bf16 v39, v19, v97, 0
    v_dot2_f32_bf16 v32, v51, v96, v32
    v_dot2_f32_bf16 v33, v17, v96, v33
    v_dot2_f32_bf16 v34, v52, v96, v34
    v_dot2_f32_bf16 v35, v18, v96, v35
    v_dot2_f32_bf16 v36, v53, v96, v36
    v_dot2_f32_bf16 v37, v19, v96, v37
    v_dot2_f32_bf16 v38, v54, v96, v38
    v_dot2_f32_bf16 v39, v20, v96, v39
    v_lshlrev_b32 v24, 16, v56
    v_and_b32 v25, v14, v56
    v_lshlrev_b32 v26, 16, v57
    v_and_b32 v27, v14, v57
    v_lshlrev_b32 v28, 16, v58
    v_and_b32 v29, v14, v58
    v_lshlrev_b32 v30, 16, v59
    v_and_b32 v31, v14, v59
    v_mul_f32 v32, v32, v24
    v_mul_f32 v33, v33, v25
    v_mul_f32 v34, v34, v26
    v_mul_f32 v35, v35, v27
    v_mul_f32 v36, v36, v28
    v_mul_f32 v37, v37, v29
    v_mul_f32 v38, v38, v30
    v_mul_f32 v39, v39, v31
    v_cvt_pk_bf16_f32 v84, v39, v38
    v_cvt_pk_bf16_f32 v85, v37, v36
    v_cvt_pk_bf16_f32 v86, v35, v34
    v_cvt_pk_bf16_f32 v87, v33, v32
    buffer_store_dwordx4 v[84:87], v3, s[48:51], s45 offen sc1
    s_cmp_ge_u32 s3, 2
    s_cbranch_scc1 .Lb_done
    s_waitcnt lgkmcnt(0)
    v_alignbit_b32 v16, v41, v40, 16
    v_alignbit_b32 v17, v42, v41, 16
    v_alignbit_b32 v18, v43, v42, 16
    v_alignbit_b32 v19, v44, v43, 16
    v_alignbit_b32 v20, v45, v44, 16
    v_dot2_f32_bf16 v32, v40, v99, 0
    v_dot2_f32_bf16 v33, v16, v99, 0
    v_dot2_f32_bf16 v34, v41, v99, 0
    v_dot2_f32_bf16 v35, v17, v99, 0
    v_dot2_f32_bf16 v36, v42, v99, 0
    v_dot2_f32_bf16 v37, v18, v99, 0
    v_dot2_f32_bf16 v38, v43, v99, 0
    v_dot2_f32_bf16 v39, v19, v99, 0
    v_dot2_f32_bf16 v32, v41, v98, v32
    v_dot2_f32_bf16 v33, v17, v98, v33
    v_dot2_f32_bf16 v34, v42, v98, v34
    v_dot2_f32_bf16 v35, v18, v98, v35
    v_dot2_f32_bf16 v36, v43, v98, v36
    v_dot2_f32_bf16 v37, v19, v98, v37
    v_dot2_f32_bf16 v38, v44, v98, v38
    v_dot2_f32_bf16 v39, v20, v98, v39
    v_lshlrev_b32 v24, 16, v46
    v_and_b32 v25, v14, v46
    v_lshlrev_b32 v26, 16, v47
    v_and_b32 v27, v14, v47
    v_lshlrev_b32 v28, 16, v48
    v_and_b32 v29, v14, v48
    v_lshlrev_b32 v30, 16, v49
    v_and_b32 v31, v14, v49
    v_mul_f32 v32, v32, v24
    v_mul_f32 v33, v33, v25
    v_mul_f32 v34, v34, v26
    v_mul_f32 v35, v35, v27
    v_mul_f32 v36, v36, v28
    v_mul_f32 v37, v37, v29
    v_mul_f32 v38, v38, v30
    v_mul_f32 v39, v39, v31
    v_cvt_pk_bf16_f32 v88, v39, v38
    v_cvt_pk_bf16_f32 v89, v37, v36
    v_cvt_pk_bf16_f32 v90, v35, v34
    v_cvt_pk_bf16_f32 v91, v33, v32
    buffer_store_dwordx4 v[88:91], v3, s[48:51], s46 offen sc1
.Lb_done:
    s_waitcnt lgkmcnt(0)
    s_cmp_lg_u32 s65, 0
    s_cbranch_scc1 .Ltagd_21
    v_mov_b32 v10, 0
    s_mov_b32 s74, 16384
.Ltag_20:
    global_load_dwordx2 v[8:9], v10, s[36:37] sc1
    s_waitcnt vmcnt(0)
    v_readfirstlane_b32 s64, v8
    v_readfirstlane_b32 s65, v9
    s_nop 0
    s_cmp_lg_u32 s65, 0
    s_cbranch_scc1 .Ltagd_21
    s_sub_u32 s74, s74, 1
    s_cbranch_scc0 .Ltag_20
.Ltagd_21:
    s_waitcnt vmcnt(0)
    s_barrier
    s_cmp_lg_u32 s3, 0
    s_cbranch_scc1 .Lb_nf
    s_lshl_b32 s66, s6, 7
    s_add_u32 s66, s66, 14879744
    v_mov_b32 v8, s64
    v_mov_b32 v9, s65
    v_mov_b32 v10, 0
    v_mov_b32 v11, 0
    v_lshlrev_b32 v12, 4, v0
    s_mov_b64 exec, 0xff
    buffer_store_dwordx4 v[8:11], v12, s[48:51], s66 offen sc1
    s_mov_b64 exec, -1
.Lb_nf:
    s_cmp_lg_u32 s3, 1
    s_cbranch_scc1 .Lb_ni
    s_getreg_b32 s67, hwreg(HW_REG_XCC_ID)
    s_lshl_b32 s66, s4, 5
    s_add_u32 s66, s66, s5
    s_lshl_b32 s66, s66, 4
    s_add_u32 s66, s66, 14927360
    v_mov_b32 v8, s64
    v_mov_b32 v9, s65
    v_mov_b32 v10, s67
    v_mov_b32 v11, 0
    s_mov_b64 exec, 1
    buffer_store_dwordx4 v[8:11], v11, s[48:51], s66 offen sc1
    s_mov_b64 exec, -1
.Lb_ni:
    s_mov_b32 s6, 0
    s_cmp_ge_u32 s3, 4
    s_cbranch_scc1 .Lunit
    s_lshl_b32 s66, s4, 2
    s_add_u32 s66, s66, s3
    s_lshl_b32 s66, s66, 5
    s_add_u32 s66, s66, s5
    s_lshl_b32 s66, s66, 7
    s_add_u32 s66, s66, 15073280
    s_load_dword s100, s[38:39], s66
    s_mul_i32 s57, s5, 5
    s_lshr_b32 s57, s57, 1
    s_and_b32 s58, s5, 1
    s_add_u32 s52, s57, s58
    s_mul_i32 s52, s52, 32768
    s_lshl_b32 s66, s58, 1
    s_sub_u32 s53, s57, s66
    s_add_u32 s53, s53, 2
    s_mul_i32 s53, s53, 32768
    s_lshl_b32 s58, s58, 3
    s_add_u32 s54, s53, s58
    s_lshl_b32 s66, s4, 1
    s_add_u32 s66, s66, s3
    s_sub_i32 s66, s66, 2
    s_lshl_b32 s67, s4, 2
    s_add_u32 s67, s67, s3
    s_lshl_b32 s55, s67, 10
    s_lshl_b32 s67, s67, 1
    s_lshl_b32 s68, s66, 2
    s_lshl_b32 s70, s66, 11
    s_cmp_ge_i32 s66, 0
    s_cselect_b32 s59, 1, 0
    s_cselect_b32 s70, s70, 1073741824
    s_cselect_b32 s56, 0x3f803f80, 0
    v_lshlrev_b32 v206, 4, v0
    v_add_u32 v202, s70, v206
    v_lshrrev_b32 v210, 2, v0
    v_mul_u32_u24 v210, s59, v210
    v_and_b32 v211, 1, v0
    v_lshl_add_u32 v211, v211, 1, s57
    v_lshrrev_b32 v211, 2, v211
    v_mad_u32_u24 v211, v210, 20, v211
    v_bfe_u32 v213, v0, 1, 1
    v_mad_u32_u24 v212, v213, 3, s68
    v_add_u32 v213, s67, v213
    v_cmp_eq_u32 vcc, 0, v210
    v_and_b32 v214, 31, v0
    v_lshrrev_b32 v215, 5, v0
    v_cndmask_b32 v212, v212, v213, vcc
    v_mul_u32_u24 v212, 52, v212
    v_lshrrev_b32 v212, 8, v212
    v_mad_u32_u24 v211, v212, 60, v211
    v_lshlrev_b32 v211, 7, v211
    v_add_u32 v200, 14680064, v211
    s_max_i32 s68, s68, 0
    v_add_u32 v210, s68, v215
    v_mul_u32_u24 v211, 52, v210
    v_lshrrev_b32 v211, 8, v211
    v_mul_u32_u24 v211, 5, v211
    v_sub_u32 v210, v210, v211
    v_cmp_gt_u32 s[60:61], 3, v210
    v_add_u32 v210, s68, v215
    v_add_u32 v210, 2, v210
    v_mul_u32_u24 v211, 52, v210
    v_lshrrev_b32 v211, 8, v211
    v_mul_u32_u24 v211, 5, v211
    v_sub_u32 v210, v210, v211
    v_cmp_gt_u32 s[62:63], 3, v210
    s_lshl_b32 s70, s4, 9
    s_add_u32 s70, s70, 14927360
    v_lshl_add_u32 v201, v214, 4, s70
    v_lshl_add_u32 v210, v214, 4, s55
    v_mul_u32_u24 v211, 32768, v215
    v_add3_u32 v203, v210, v211, s52
    v_lshl_add_u32 v204, v215, 30, v210
    s_lshl_b32 s66, s3, 11
    s_sub_u32 s66, s66, s58
    s_add_u32 s66, s66, 41288
    v_add_u32 v205, s66, v206
    s_lshl_b32 s70, s3, 10
    v_lshl_add_u32 v210, v214, 4, s70
    v_mul_u32_u24 v211, 8256, v215
    v_add_u32 v207, v210, v211
    s_add_u32 s66, s58, 16512
    v_add_u32 v208, s66, v210
    v_bfe_u32 v210, v0, 2, 2
    v_lshl_add_u32 v210, v215, 2, v210
    v_bfe_u32 v211, v0, 1, 1
    v_mul_u32_u24 v211, 8256, v211
    v_and_b32 v212, 1, v0
    v_lshl_add_u32 v211, v212, 3, v211
    v_and_b32 v212, 3, v0
    v_min_u32 v212, 1, v212
    v_lshlrev_b32 v212, 3, v212
    v_xor_b32 v212, s58, v212
    v_and_b32 v213, 16, v0
    v_cmp_eq_u32 vcc, 0, v213
    v_add_u32 v212, 16512, v212
    s_add_u32 s70, s70, 24768
    v_cndmask_b32 v211, v212, v211, vcc
    v_lshl_add_u32 v210, v210, 4, v211
    v_add_u32 v209, s70, v210
    v_mov_b32 v8, 163616
    s_mov_b32 s74, 65536
.Llw_22:
    ds_read_b32 v9, v8
    s_waitcnt lgkmcnt(0)
    v_readfirstlane_b32 s72, v9
    s_nop 0
    s_cmp_ge_u32 s72, 4
    s_cbranch_scc1 .Llwd_23
    s_sleep 4
    s_sub_u32 s74, s74, 1
    s_cbranch_scc0 .Llw_22
.Llwd_23:
    s_branch .La_att
.Ltouch:
    s_waitcnt lgkmcnt(0)
    s_sub_u32 s10, s6, 52
    s_lshl_b32 s10, s10, 3
    s_add_u32 s10, s10, s3
    s_cmp_lg_u32 s10, 0
    s_cbranch_scc1 .Lt_notag
    s_memrealtime s[66:67]
    s_waitcnt lgkmcnt(0)
    s_or_b32 s67, s67, 0x5a000000
    v_mov_b32 v8, s66
    v_mov_b32 v9, s67
    v_mov_b32 v10, 0
    s_mov_b64 exec, 1
    global_store_dwordx2 v10, v[8:9], s[36:37] sc1
    s_mov_b64 exec, -1
.Lt_notag:
    s_mov_b32 s48, s38
    s_mov_b32 s49, s39
    s_mov_b32 s50, 20971520
    s_mov_b32 s51, 0x20000
    s_mov_b32 s40, s20
    s_mov_b32 s41, s21
    s_mov_b32 s42, 819200
    s_mov_b32 s43, 0x20000
    s_sub_u32 s11, s6, 52
    s_mul_i32 s12, s3, 5120
    v_lshlrev_b32 v2, 4, v0
    s_mul_i32 s66, s11, 40960
    s_add_u32 s66, s66, s12
    s_add_u32 m0, s12, 0
    s_nop 0
    buffer_load_dwordx4 v2, s[40:43], s66 offen offset:0 nt lds
    buffer_load_dwordx4 v2, s[40:43], s66 offen offset:1024 nt lds
    buffer_load_dwordx4 v2, s[40:43], s66 offen offset:2048 nt lds
    buffer_load_dwordx4 v2, s[40:43], s66 offen offset:3072 nt lds
    s_add_u32 s66, s66, 4096
    s_add_u32 m0, s12, 4096
    s_nop 0
    buffer_load_dwordx4 v2, s[40:43], s66 offen nt lds
    s_barrier
    s_mul_i32 s66, s11, 40960
    s_add_u32 s66, s66, s12
    s_add_u32 s66, s66, 368640
    s_add_u32 m0, s12, 40960
    s_nop 0
    buffer_load_dwordx4 v2, s[40:43], s66 offen offset:0 nt lds
    buffer_load_dwordx4 v2, s[40:43], s66 offen offset:1024 nt lds
    buffer_load_dwordx4 v2, s[40:43], s66 offen offset:2048 nt lds
    buffer_load_dwordx4 v2, s[40:43], s66 offen offset:3072 nt lds
    s_add_u32 s66, s66, 4096
    s_add_u32 m0, s12, 45056
    s_nop 0
    buffer_load_dwordx4 v2, s[40:43], s66 offen nt lds
    s_barrier
    s_mul_i32 s66, s11, 40960
    s_add_u32 s66, s66, s12
    s_add_u32 s66, s66, 737280
    s_add_u32 m0, s12, 81920
    s_nop 0
    buffer_load_dwordx4 v2, s[40:43], s66 offen offset:0 nt lds
    buffer_load_dwordx4 v2, s[40:43], s66 offen offset:1024 nt lds
    buffer_load_dwordx4 v2, s[40:43], s66 offen offset:2048 nt lds
    buffer_load_dwordx4 v2, s[40:43], s66 offen offset:3072 nt lds
    s_add_u32 s66, s66, 4096
    s_add_u32 m0, s12, 86016
    s_nop 0
    buffer_load_dwordx4 v2, s[40:43], s66 offen nt lds
    s_barrier
    s_and_b32 s71, s3, 3
    s_mov_b32 s0, 4
    s_add_u32 s8, s11, 311
    s_lshl_b32 s8, s8, 1
    s_and_b32 s9, s71, 2
    s_cmp_eq_u32 s0, 8
    s_cselect_b32 s9, 0, s9
    s_add_u32 s8, s8, s71
    s_sub_u32 s8, s8, s9
    s_mov_b32 s60, s30
    s_mov_b32 s61, s31
    s_mov_b32 s62, 2621440
    s_mov_b32 s63, 0x20000
    s_lshl_b32 s66, s8, 12
    s_cmp_eq_u32 s9, 0
    s_cselect_b32 s66, s66, 1073741824
    s_cmp_ge_u32 s3, 4
    s_cselect_b32 s66, s66, 1073741824
    v_lshlrev_b32 v15, 4, v0
    buffer_load_dwordx4 v[216:219], v15, s[60:63], s66 offen offset:0 nt
    buffer_load_dwordx4 v[220:223], v15, s[60:63], s66 offen offset:1024 nt
    buffer_load_dwordx4 v[224:227], v15, s[60:63], s66 offen offset:2048 nt
    buffer_load_dwordx4 v[228:231], v15, s[60:63], s66 offen offset:3072 nt
    s_lshr_b32 s67, s8, 1
    s_lshl_b32 s67, s67, 2
    s_load_dword s1, s[32:33], s67
    v_mov_b32 v9, 0
    v_lshlrev_b32 v8, 2, v0
    v_add_u32 v8, 163584, v8
    ds_write_b32 v8, v9
    s_and_b32 s66, s5, 7
    s_mul_i32 s66, s66, 20
    s_add_u32 s66, s66, s71
    s_lshl_b32 s66, s66, 7
    s_add_u32 s66, s66, 14931456
    v_min_u32 v197, 4, v0
    v_lshl_add_u32 v197, v197, 9, s66
    v_and_b32 v200, 15, v0
    v_lshrrev_b32 v201, 4, v0
    v_lshl_add_u32 v211, v200, 1, v201
    s_lshl_b32 s66, s9, 3
    s_sub_u32 s66, 30, s66
    v_add_u32 v211, s66, v211
    v_lshlrev_b32 v210, 6, v211
    v_add_u32 v210, 145152, v210
    v_lshlrev_b32 v211, 2, v211
    v_lshlrev_b32 v202, 3, v201
    v_sub_u32 v202, v200, v202
    v_add_u32 v202, 25, v202
    v_and_b32 v203, 1, v202
    v_mul_u32_u24 v203, 4160, v203
    v_lshrrev_b32 v202, 1, v202
    v_lshl_add_u32 v202, v202, 2, v203
    s_sub_u32 s67, s71, s9
    s_mul_i32 s67, s67, 8320
    s_lshl_b32 s66, s9, 7
    s_add_u32 s66, s66, s67
    s_add_u32 s66, s66, 111872
    v_add_u32 v205, s66, v202
    v_add_u32 v206, 1024, v205
    v_add_u32 v207, 2048, v205
    v_add_u32 v208, 3072, v205
    v_and_b32 v202, 7, v200
    v_sub_u32 v202, 7, v202
    v_and_b32 v203, 1, v202
    v_lshlrev_b32 v203, 4, v203
    v_mov_b32 v204, 0xffff
    v_lshlrev_b32 v203, v203, v204
    v_lshrrev_b32 v204, 3, v200
    v_add_u32 v204, 2, v204
    v_cmp_eq_u32 vcc, v204, v201
    v_lshrrev_b32 v202, 1, v202
    s_nop 0
    v_cndmask_b32 v203, 0, v203, vcc
    v_cmp_eq_u32 vcc, 0, v202
    s_nop 1
    v_cndmask_b32 v176, 0, v203, vcc
    v_cmp_eq_u32 vcc, 1, v202
    s_nop 1
    v_cndmask_b32 v177, 0, v203, vcc
    v_cmp_eq_u32 vcc, 2, v202
    s_nop 1
    v_cndmask_b32 v178, 0, v203, vcc
    v_cmp_eq_u32 vcc, 3, v202
    s_nop 1
    v_cndmask_b32 v179, 0, v203, vcc
    v_and_b32 v212, 1, v201
    v_lshlrev_b32 v212, 9, v212
    v_lshrrev_b32 v202, 1, v201
    v_lshl_add_u32 v212, v202, 6, v212
    v_lshrrev_b32 v202, 2, v200
    v_lshl_add_u32 v212, v202, 7, v212
    v_and_b32 v202, 3, v200
    v_lshl_add_u32 v212, v202, 4, v212
    s_mul_i32 s66, s71, 13
    s_sub_u32 s66, s66, 1
    s_max_i32 s66, s66, 0
    s_lshl_b32 s66, s66, 7
    s_add_u32 s66, s66, 14879744
    v_lshl_add_u32 v213, v0, 7, s66
    v_lshrrev_b32 v202, 2, v0
    v_mul_u32_u24 v202, 10368, v202
    v_xor_b32 v203, v201, v0
    v_and_b32 v203, 3, v203
    v_lshl_add_u32 v202, v203, 4, v202
    s_mul_i32 s66, s71, 663552
    s_lshr_b32 s67, s8, 2
    s_lshl_b32 s67, s67, 6
    s_add_u32 s66, s66, s67
    v_add_u32 v214, s66, v202
    v_cmp_lt_u32 vcc, 19, v0
    s_nop 1
    v_cndmask_b32 v192, 0, 1, vcc
    v_mul_u32_u24 v201, 20, v192
    v_sub_u32 v201, v0, v201
    s_lshl_b32 s67, s71, 4
    v_lshl_add_u32 v202, v192, 6, s67
    v_and_b32 v203, 7, v201
    v_lshlrev_b32 v203, 4, v203
    v_xor_b32 v202, v202, v203
    v_lshl_add_u32 v202, v201, 9, v202
    v_add_u32 v193, 152064, v202
    s_lshl_b32 s67, s71, 1
    v_add_u32 v192, s67, v192
    v_mul_u32_u24 v192, 10240, v192
    v_lshlrev_b32 v201, 3, v201
    v_mov_b32 v203, 1073741824
    v_cmp_gt_u32 vcc, 40, v0
    s_nop 1
    v_cndmask_b32 v201, v203, v201, vcc
    v_lshl_add_u32 v195, v192, 1, v201
    v_add_u32 v192, v192, v201
    s_mul_i32 s67, s71, 20
    v_lshrrev_b32 v201, 3, v0
    s_add_u32 s68, s67, 0
    v_add_u32 v202, s68, v201
    v_lshrrev_b32 v203, 2, v202
    v_xor_b32 v203, v203, v0
    v_and_b32 v203, 7, v203
    v_lshlrev_b32 v202, 12, v202
    v_lshl_add_u32 v189, v203, 4, v202
    s_add_u32 s68, s67, 8
    v_add_u32 v202, s68, v201
    v_lshrrev_b32 v203, 2, v202
    v_xor_b32 v203, v203, v0
    v_and_b32 v203, 7, v203
    v_lshlrev_b32 v202, 12, v202
    v_lshl_add_u32 v190, v203, 4, v202
    s_add_u32 s68, s67, 16
    v_add_u32 v202, s68, v201
    v_lshrrev_b32 v203, 2, v202
    v_xor_b32 v203, v203, v0
    v_and_b32 v203, 7, v203
    v_lshlrev_b32 v202, 12, v202
    v_lshl_add_u32 v191, v203, 4, v202
    s_and_b32 s66, s5, 7
    s_mul_i32 s66, s66, 40
    s_mul_i32 s67, s71, 10
    s_add_u32 s66, s66, s67
    s_lshl_b32 s66, s66, 7
    s_add_u32 s66, s66, 14886400
    v_lshl_add_u32 v194, v0, 7, s66
    v_mov_b32 v196, 0xffff0000
    v_lshrrev_b32 v5, 4, v0
    v_bfe_u32 v6, v0, 2, 2
    v_lshl_add_u32 v5, v5, 3, v6
    v_mul_u32_u24 v5, 1280, v5
    v_and_b32 v6, 3, v0
    v_lshl_add_u32 v5, v6, 3, v5
    s_mul_i32 s66, s3, 160
    v_add_u32 v5, s66, v5
    s_mul_i32 s13, s3, 20
    s_add_u32 s13, s13, s11
    s_mul_i32 s12, s13, 5120
    s_add_u32 s12, s12, 15728640
    s_waitcnt vmcnt(14) lgkmcnt(0)
    s_barrier
    ds_read_b64_tr_b16 v[16:17], v5 offset:0
    ds_read_b64_tr_b16 v[18:19], v5 offset:5120
    ds_read_b64_tr_b16 v[20:21], v5 offset:32
    ds_read_b64_tr_b16 v[22:23], v5 offset:5152
    ds_read_b64_tr_b16 v[24:25], v5 offset:64
    ds_read_b64_tr_b16 v[26:27], v5 offset:5184
    ds_read_b64_tr_b16 v[28:29], v5 offset:96
    ds_read_b64_tr_b16 v[30:31], v5 offset:5216
    ds_read_b64_tr_b16 v[32:33], v5 offset:128
    ds_read_b64_tr_b16 v[34:35], v5 offset:5248
    v_add_u32 v5, 40960, v5
    s_add_u32 s14, s12, 4096
    s_waitcnt lgkmcnt(0)
    buffer_store_dwordx4 v[16:19], v2, s[48:51], s12 offen offset:0 sc1
    buffer_store_dwordx4 v[20:23], v2, s[48:51], s12 offen offset:1024 sc1
    buffer_store_dwordx4 v[24:27], v2, s[48:51], s12 offen offset:2048 sc1
    buffer_store_dwordx4 v[28:31], v2, s[48:51], s12 offen offset:3072 sc1
    buffer_store_dwordx4 v[32:35], v2, s[48:51], s14 offen offset:0 sc1
    s_add_u32 s12, s12, 46080
    s_waitcnt vmcnt(14) lgkmcnt(0)
    s_barrier
    s_load_dwordx2 s[64:65], s[36:37], 0
    ds_read_b64_tr_b16 v[36:37], v5 offset:0
    ds_read_b64_tr_b16 v[38:39], v5 offset:5120
    ds_read_b64_tr_b16 v[40:41], v5 offset:32
    ds_read_b64_tr_b16 v[42:43], v5 offset:5152
    ds_read_b64_tr_b16 v[44:45], v5 offset:64
    ds_read_b64_tr_b16 v[46:47], v5 offset:5184
    ds_read_b64_tr_b16 v[48:49], v5 offset:96
    ds_read_b64_tr_b16 v[50:51], v5 offset:5216
    ds_read_b64_tr_b16 v[52:53], v5 offset:128
    ds_read_b64_tr_b16 v[54:55], v5 offset:5248
    v_add_u32 v5, 40960, v5
    s_add_u32 s14, s12, 4096
    s_waitcnt lgkmcnt(0)
    buffer_store_dwordx4 v[36:39], v2, s[48:51], s12 offen offset:0 sc1
    buffer_store_dwordx4 v[40:43], v2, s[48:51], s12 offen offset:1024 sc1
    buffer_store_dwordx4 v[44:47], v2, s[48:51], s12 offen offset:2048 sc1
    buffer_store_dwordx4 v[48:51], v2, s[48:51], s12 offen offset:3072 sc1
    buffer_store_dwordx4 v[52:55], v2, s[48:51], s14 offen offset:0 sc1
    s_add_u32 s12, s12, 46080
    s_waitcnt vmcnt(10) lgkmcnt(0)
    s_barrier
    s_cmp_ge_u32 s11, 2
    s_cbranch_scc1 .Lt_two
    ds_read_b64_tr_b16 v[56:57], v5 offset:0
    ds_read_b64_tr_b16 v[58:59], v5 offset:5120
    ds_read_b64_tr_b16 v[60:61], v5 offset:32
    ds_read_b64_tr_b16 v[62:63], v5 offset:5152
    ds_read_b64_tr_b16 v[64:65], v5 offset:64
    ds_read_b64_tr_b16 v[66:67], v5 offset:5184
    ds_read_b64_tr_b16 v[68:69], v5 offset:96
    ds_read_b64_tr_b16 v[70:71], v5 offset:5216
    ds_read_b64_tr_b16 v[72:73], v5 offset:128
    ds_read_b64_tr_b16 v[74:75], v5 offset:5248
    v_add_u32 v5, 40960, v5
    s_add_u32 s14, s12, 4096
    s_waitcnt lgkmcnt(0)
    buffer_store_dwordx4 v[56:59], v2, s[48:51], s12 offen offset:0 sc1
    buffer_store_dwordx4 v[60:63], v2, s[48:51], s12 offen offset:1024 sc1
    buffer_store_dwordx4 v[64:67], v2, s[48:51], s12 offen offset:2048 sc1
    buffer_store_dwordx4 v[68:71], v2, s[48:51], s12 offen offset:3072 sc1
    buffer_store_dwordx4 v[72:75], v2, s[48:51], s14 offen offset:0 sc1
    s_add_u32 s12, s12, 46080
.Lt_two:
    s_waitcnt lgkmcnt(0)
    s_cmp_lg_u32 s65, 0
    s_cbranch_scc1 .Ltagd_25
    v_mov_b32 v10, 0
    s_mov_b32 s74, 16384
.Ltag_24:
    global_load_dwordx2 v[8:9], v10, s[36:37] sc1
    s_waitcnt vmcnt(0)
    v_readfirstlane_b32 s64, v8
    v_readfirstlane_b32 s65, v9
    s_nop 0
    s_cmp_lg_u32 s65, 0
    s_cbranch_scc1 .Ltagd_25
    s_sub_u32 s74, s74, 1
    s_cbranch_scc0 .Ltag_24
.Ltagd_25:
    s_lshl_b32 s13, s13, 7
    s_add_u32 s13, s13, 14931456
    s_waitcnt vmcnt(0)
    v_mov_b32 v8, s64
    v_mov_b32 v9, s65
    v_mov_b32 v10, 0
    v_mov_b32 v11, 0
    v_lshlrev_b32 v12, 4, v0
    s_mov_b64 exec, 0xff
    buffer_store_dwordx4 v[8:11], v12, s[48:51], s13 offen sc1
    s_mov_b64 exec, -1
    s_add_u32 s13, s13, 1152
    v_mov_b32 v8, s64
    v_mov_b32 v9, s65
    v_mov_b32 v10, 0
    v_mov_b32 v11, 0
    v_lshlrev_b32 v12, 4, v0
    s_mov_b64 exec, 0xff
    buffer_store_dwordx4 v[8:11], v12, s[48:51], s13 offen sc1
    s_mov_b64 exec, -1
    s_add_u32 s13, s13, 1152
    s_cmp_ge_u32 s11, 2
    s_cbranch_scc1 .Lt_fl
    v_mov_b32 v8, s64
    v_mov_b32 v9, s65
    v_mov_b32 v10, 0
    v_mov_b32 v11, 0
    v_lshlrev_b32 v12, 4, v0
    s_mov_b64 exec, 0xff
    buffer_store_dwordx4 v[8:11], v12, s[48:51], s13 offen sc1
    s_mov_b64 exec, -1
    s_add_u32 s13, s13, 1152
.Lt_fl:
    s_barrier
    s_branch .Lb_nf
.Lawave:
    s_setprio 2
    v_mov_b32 v169, 0
    v_lshlrev_b32 v168, 2, v0
    v_add_u32 v168, 163584, v168
    ds_write_b32 v168, v169
    v_lshrrev_b32 v5, 4, v0
    v_bfe_u32 v7, v0, 2, 2
    v_lshl_add_u32 v1, v5, 3, v7
    v_lshlrev_b32 v1, 8, v1
    v_xor_b32 v7, s3, v7
    v_lshl_add_u32 v1, v7, 6, v1
    v_and_b32 v7, 1, v5
    v_lshl_add_u32 v1, v7, 5, v1
    v_and_b32 v7, 3, v0
    v_lshl_add_u32 v1, v7, 3, v1
    v_xor_b32 v2, 32, v1
    v_and_b32 v7, 15, v0
    v_lshrrev_b32 v3, 1, v7
    v_xor_b32 v3, v3, v5
    v_lshlrev_b32 v3, 4, v3
    v_lshl_add_u32 v3, v7, 7, v3
    v_add_u32 v3, 16384, v3
    v_xor_b32 v4, 64, v3
    v_lshrrev_b32 v6, 5, v0
    v_and_b32 v7, 31, v0
    s_lshl_b32 s66, s7, 4
    s_lshl_b32 s67, s3, 2
    s_add_u32 s66, s66, s67
    v_add_u32 v6, s66, v6
    v_mul_u32_u24 v6, 32768, v6
    v_lshl_add_u32 v6, v7, 4, v6
    s_mul_i32 s66, s6, 2560
    v_add_u32 v6, s66, v6
    s_cmp_lt_u32 s7, 5
    s_cselect_b32 s10, 0x3ea52b5c, 1.0
    s_mov_b32 s11, 65536
    s_mul_i32 s12, s6, 60
    s_lshl_b32 s67, s7, 2
    s_add_u32 s12, s12, s67
    s_add_u32 s12, s12, s3
    s_lshl_b32 s12, s12, 7
    s_add_u32 s12, s12, 14680064
    s_add_u32 s13, s12, 99840
    s_mov_b32 s14, 98304
    s_cmp_eq_u32 s6, 12
    s_cselect_b32 s14, 40960, s14
    s_waitcnt lgkmcnt(0)
    s_mov_b32 s48, s38
    s_mov_b32 s49, s39
    s_mov_b32 s50, 20971520
    s_mov_b32 s51, 0x20000
    s_barrier
    ds_read_b64_tr_b16 v[8:9], v1 offset:0
    ds_read_b64_tr_b16 v[10:11], v1 offset:1024
    ds_read_b64_tr_b16 v[12:13], v2 offset:0
    ds_read_b64_tr_b16 v[14:15], v2 offset:1024
    ds_read_b128 v[232:235], v3 offset:0
    ds_read_b128 v[236:239], v3 offset:2048
    ds_read_b128 v[240:243], v3 offset:4096
    ds_read_b128 v[244:247], v3 offset:6144
    ds_read_b128 v[248:251], v3 offset:8192
    s_waitcnt lgkmcnt(4)
    v_mfma_f32_16x16x32_bf16 v[168:171], v[8:11], v[232:235], 0
    ds_read_b128 v[252:255], v3 offset:10240
    v_mfma_f32_16x16x32_bf16 v[176:179], v[12:15], v[232:235], 0
    s_waitcnt lgkmcnt(4)
    v_mfma_f32_16x16x32_bf16 v[180:183], v[12:15], v[236:239], 0
    ds_read_b64_tr_b16 v[16:17], v1 offset:8192
    ds_read_b64_tr_b16 v[18:19], v1 offset:9216
    ds_read_b64_tr_b16 v[20:21], v2 offset:8192
    v_mfma_f32_16x16x32_bf16 v[172:175], v[8:11], v[236:239], 0
    ds_read_b64_tr_b16 v[22:23], v2 offset:9216
    ds_read_b128 v[232:235], v4 offset:0
    s_waitcnt lgkmcnt(8)
    v_mfma_f32_16x16x32_bf16 v[184:187], v[8:11], v[240:243], 0
    ds_read_b128 v[236:239], v4 offset:2048
    v_mfma_f32_16x16x32_bf16 v[192:195], v[12:15], v[240:243], 0
    s_waitcnt lgkmcnt(8)
    v_mfma_f32_16x16x32_bf16 v[196:199], v[12:15], v[244:247], 0
    ds_read_b128 v[240:243], v4 offset:4096
    v_mfma_f32_16x16x32_bf16 v[188:191], v[8:11], v[244:247], 0
    s_waitcnt lgkmcnt(8)
    v_mfma_f32_16x16x32_bf16 v[200:203], v[8:11], v[248:251], 0
    ds_read_b128 v[244:247], v4 offset:6144
    v_mfma_f32_16x16x32_bf16 v[208:211], v[12:15], v[248:251], 0
    s_waitcnt lgkmcnt(8)
    v_mfma_f32_16x16x32_bf16 v[212:215], v[12:15], v[252:255], 0
    ds_read_b128 v[248:251], v4 offset:8192
    v_mfma_f32_16x16x32_bf16 v[204:207], v[8:11], v[252:255], 0
    s_waitcnt lgkmcnt(4)
    v_mfma_f32_16x16x32_bf16 v[168:171], v[16:19], v[232:235], v[168:171]
    ds_read_b128 v[252:255], v4 offset:10240
    v_mfma_f32_16x16x32_bf16 v[176:179], v[20:23], v[232:235], v[176:179]
    s_waitcnt lgkmcnt(4)
    v_mfma_f32_16x16x32_bf16 v[180:183], v[20:23], v[236:239], v[180:183]
    s_barrier
    ds_read_b64_tr_b16 v[24:25], v1 offset:28672
    ds_read_b64_tr_b16 v[26:27], v1 offset:29696
    ds_read_b64_tr_b16 v[28:29], v2 offset:28672
    v_mfma_f32_16x16x32_bf16 v[172:175], v[16:19], v[236:239], v[172:175]
    ds_read_b64_tr_b16 v[30:31], v2 offset:29696
    ds_read_b128 v[232:235], v3 offset:28672
    s_waitcnt lgkmcnt(8)
    v_mfma_f32_16x16x32_bf16 v[184:187], v[16:19], v[240:243], v[184:187]
    ds_read_b128 v[236:239], v3 offset:30720
    v_mfma_f32_16x16x32_bf16 v[192:195], v[20:23], v[240:243], v[192:195]
    s_waitcnt lgkmcnt(8)
    v_mfma_f32_16x16x32_bf16 v[196:199], v[20:23], v[244:247], v[196:199]
    ds_read_b128 v[240:243], v3 offset:32768
    v_mfma_f32_16x16x32_bf16 v[188:191], v[16:19], v[244:247], v[188:191]
    s_waitcnt lgkmcnt(8)
    v_mfma_f32_16x16x32_bf16 v[200:203], v[16:19], v[248:251], v[200:203]
    ds_read_b128 v[244:247], v3 offset:34816
    v_mfma_f32_16x16x32_bf16 v[208:211], v[20:23], v[248:251], v[208:211]
    s_waitcnt lgkmcnt(8)
    v_mfma_f32_16x16x32_bf16 v[212:215], v[20:23], v[252:255], v[212:215]
    ds_read_b128 v[248:251], v3 offset:36864
    v_mfma_f32_16x16x32_bf16 v[204:207], v[16:19], v[252:255], v[204:207]
    s_waitcnt lgkmcnt(4)
    v_mfma_f32_16x16x32_bf16 v[168:171], v[24:27], v[232:235], v[168:171]
    ds_read_b128 v[252:255], v3 offset:38912
    v_mfma_f32_16x16x32_bf16 v[176:179], v[28:31], v[232:235], v[176:179]
    s_waitcnt lgkmcnt(4)
    v_mfma_f32_16x16x32_bf16 v[180:183], v[28:31], v[236:239], v[180:183]
    ds_read_b64_tr_b16 v[32:33], v1 offset:36864
    ds_read_b64_tr_b16 v[34:35], v1 offset:37888
    ds_read_b64_tr_b16 v[36:37], v2 offset:36864
    v_mfma_f32_16x16x32_bf16 v[172:175], v[24:27], v[236:239], v[172:175]
    ds_read_b64_tr_b16 v[38:39], v2 offset:37888
    ds_read_b128 v[232:235], v4 offset:28672
    s_waitcnt lgkmcnt(8)
    v_mfma_f32_16x16x32_bf16 v[184:187], v[24:27], v[240:243], v[184:187]
    ds_read_b128 v[236:239], v4 offset:30720
    v_mfma_f32_16x16x32_bf16 v[192:195], v[28:31], v[240:243], v[192:195]
    s_waitcnt lgkmcnt(8)
    v_mfma_f32_16x16x32_bf16 v[196:199], v[28:31], v[244:247], v[196:199]
    ds_read_b128 v[240:243], v4 offset:32768
    v_mfma_f32_16x16x32_bf16 v[188:191], v[24:27], v[244:247], v[188:191]
    s_waitcnt lgkmcnt(8)
    v_mfma_f32_16x16x32_bf16 v[200:203], v[24:27], v[248:251], v[200:203]
    ds_read_b128 v[244:247], v4 offset:34816
    v_mfma_f32_16x16x32_bf16 v[208:211], v[28:31], v[248:251], v[208:211]
    s_waitcnt lgkmcnt(8)
    v_mfma_f32_16x16x32_bf16 v[212:215], v[28:31], v[252:255], v[212:215]
    ds_read_b128 v[248:251], v4 offset:36864
    v_mfma_f32_16x16x32_bf16 v[204:207], v[24:27], v[252:255], v[204:207]
    s_waitcnt lgkmcnt(4)
    v_mfma_f32_16x16x32_bf16 v[168:171], v[32:35], v[232:235], v[168:171]
    ds_read_b128 v[252:255], v4 offset:38912
    v_mfma_f32_16x16x32_bf16 v[176:179], v[36:39], v[232:235], v[176:179]
    s_waitcnt lgkmcnt(4)
    v_mfma_f32_16x16x32_bf16 v[180:183], v[36:39], v[236:239], v[180:183]
    v_add_u32 v1, 57344, v1
    v_add_u32 v2, 57344, v2
    v_add_u32 v3, 57344, v3
    v_add_u32 v4, 57344, v4
    s_barrier
    ds_read_b64_tr_b16 v[40:41], v1 offset:0
    ds_read_b64_tr_b16 v[42:43], v1 offset:1024
    ds_read_b64_tr_b16 v[44:45], v2 offset:0
    v_mfma_f32_16x16x32_bf16 v[172:175], v[32:35], v[236:239], v[172:175]
    ds_read_b64_tr_b16 v[46:47], v2 offset:1024
    ds_read_b128 v[232:235], v3 offset:0
    s_waitcnt lgkmcnt(8)
    v_mfma_f32_16x16x32_bf16 v[184:187], v[32:35], v[240:243], v[184:187]
    ds_read_b128 v[236:239], v3 offset:2048
    v_mfma_f32_16x16x32_bf16 v[192:195], v[36:39], v[240:243], v[192:195]
    s_waitcnt lgkmcnt(8)
    v_mfma_f32_16x16x32_bf16 v[196:199], v[36:39], v[244:247], v[196:199]
    ds_read_b128 v[240:243], v3 offset:4096
    v_mfma_f32_16x16x32_bf16 v[188:191], v[32:35], v[244:247], v[188:191]
    s_waitcnt lgkmcnt(8)
    v_mfma_f32_16x16x32_bf16 v[200:203], v[32:35], v[248:251], v[200:203]
    ds_read_b128 v[244:247], v3 offset:6144
    v_mfma_f32_16x16x32_bf16 v[208:211], v[36:39], v[248:251], v[208:211]
    s_waitcnt lgkmcnt(8)
    v_mfma_f32_16x16x32_bf16 v[212:215], v[36:39], v[252:255], v[212:215]
    ds_read_b128 v[248:251], v3 offset:8192
    v_mfma_f32_16x16x32_bf16 v[204:207], v[32:35], v[252:255], v[204:207]
    s_waitcnt lgkmcnt(4)
    v_mfma_f32_16x16x32_bf16 v[168:171], v[40:43], v[232:235], v[168:171]
    ds_read_b128 v[252:255], v3 offset:10240
    v_mfma_f32_16x16x32_bf16 v[176:179], v[44:47], v[232:235], v[176:179]
    s_waitcnt lgkmcnt(4)
    v_mfma_f32_16x16x32_bf16 v[180:183], v[44:47], v[236:239], v[180:183]
    ds_read_b64_tr_b16 v[48:49], v1 offset:8192
    ds_read_b64_tr_b16 v[50:51], v1 offset:9216
    ds_read_b64_tr_b16 v[52:53], v2 offset:8192
    v_mfma_f32_16x16x32_bf16 v[172:175], v[40:43], v[236:239], v[172:175]
    ds_read_b64_tr_b16 v[54:55], v2 offset:9216
    ds_read_b128 v[232:235], v4 offset:0
    s_waitcnt lgkmcnt(8)
    v_mfma_f32_16x16x32_bf16 v[184:187], v[40:43], v[240:243], v[184:187]
    ds_read_b128 v[236:239], v4 offset:2048
    v_mfma_f32_16x16x32_bf16 v[192:195], v[44:47], v[240:243], v[192:195]
    s_waitcnt lgkmcnt(8)
    v_mfma_f32_16x16x32_bf16 v[196:199], v[44:47], v[244:247], v[196:199]
    ds_read_b128 v[240:243], v4 offset:4096
    v_mfma_f32_16x16x32_bf16 v[188:191], v[40:43], v[244:247], v[188:191]
    s_waitcnt lgkmcnt(8)
    v_mfma_f32_16x16x32_bf16 v[200:203], v[40:43], v[248:251], v[200:203]
    ds_read_b128 v[244:247], v4 offset:6144
    v_mfma_f32_16x16x32_bf16 v[208:211], v[44:47], v[248:251], v[208:211]
    s_waitcnt lgkmcnt(8)
    v_mfma_f32_16x16x32_bf16 v[212:215], v[44:47], v[252:255], v[212:215]
    ds_read_b128 v[248:251], v4 offset:8192
    v_mfma_f32_16x16x32_bf16 v[204:207], v[40:43], v[252:255], v[204:207]
    s_waitcnt lgkmcnt(4)
    v_mfma_f32_16x16x32_bf16 v[168:171], v[48:51], v[232:235], v[168:171]
    ds_read_b128 v[252:255], v4 offset:10240
    v_mfma_f32_16x16x32_bf16 v[176:179], v[52:55], v[232:235], v[176:179]
    s_waitcnt lgkmcnt(4)
    v_mfma_f32_16x16x32_bf16 v[180:183], v[52:55], v[236:239], v[180:183]
    s_barrier
    ds_read_b64_tr_b16 v[56:57], v1 offset:28672
    ds_read_b64_tr_b16 v[58:59], v1 offset:29696
    ds_read_b64_tr_b16 v[60:61], v2 offset:28672
    v_mfma_f32_16x16x32_bf16 v[172:175], v[48:51], v[236:239], v[172:175]
    ds_read_b64_tr_b16 v[62:63], v2 offset:29696
    ds_read_b128 v[232:235], v3 offset:28672
    s_waitcnt lgkmcnt(8)
    v_mfma_f32_16x16x32_bf16 v[184:187], v[48:51], v[240:243], v[184:187]
    ds_read_b128 v[236:239], v3 offset:30720
    v_mfma_f32_16x16x32_bf16 v[192:195], v[52:55], v[240:243], v[192:195]
    s_waitcnt lgkmcnt(8)
    v_mfma_f32_16x16x32_bf16 v[196:199], v[52:55], v[244:247], v[196:199]
    ds_read_b128 v[240:243], v3 offset:32768
    v_mfma_f32_16x16x32_bf16 v[188:191], v[48:51], v[244:247], v[188:191]
    s_waitcnt lgkmcnt(8)
    v_mfma_f32_16x16x32_bf16 v[200:203], v[48:51], v[248:251], v[200:203]
    ds_read_b128 v[244:247], v3 offset:34816
    v_mfma_f32_16x16x32_bf16 v[208:211], v[52:55], v[248:251], v[208:211]
    s_waitcnt lgkmcnt(8)
    v_mfma_f32_16x16x32_bf16 v[212:215], v[52:55], v[252:255], v[212:215]
    ds_read_b128 v[248:251], v3 offset:36864
    v_mfma_f32_16x16x32_bf16 v[204:207], v[48:51], v[252:255], v[204:207]
    s_waitcnt lgkmcnt(4)
    v_mfma_f32_16x16x32_bf16 v[168:171], v[56:59], v[232:235], v[168:171]
    ds_read_b128 v[252:255], v3 offset:38912
    v_mfma_f32_16x16x32_bf16 v[176:179], v[60:63], v[232:235], v[176:179]
    s_waitcnt lgkmcnt(4)
    v_mfma_f32_16x16x32_bf16 v[180:183], v[60:63], v[236:239], v[180:183]
    ds_read_b64_tr_b16 v[64:65], v1 offset:36864
    ds_read_b64_tr_b16 v[66:67], v1 offset:37888
    ds_read_b64_tr_b16 v[68:69], v2 offset:36864
    v_mfma_f32_16x16x32_bf16 v[172:175], v[56:59], v[236:239], v[172:175]
    ds_read_b64_tr_b16 v[70:71], v2 offset:37888
    ds_read_b128 v[232:235], v4 offset:28672
    s_waitcnt lgkmcnt(8)
    v_mfma_f32_16x16x32_bf16 v[184:187], v[56:59], v[240:243], v[184:187]
    ds_read_b128 v[236:239], v4 offset:30720
    v_mfma_f32_16x16x32_bf16 v[192:195], v[60:63], v[240:243], v[192:195]
    s_waitcnt lgkmcnt(8)
    v_mfma_f32_16x16x32_bf16 v[196:199], v[60:63], v[244:247], v[196:199]
    ds_read_b128 v[240:243], v4 offset:32768
    v_mfma_f32_16x16x32_bf16 v[188:191], v[56:59], v[244:247], v[188:191]
    s_waitcnt lgkmcnt(8)
    v_mfma_f32_16x16x32_bf16 v[200:203], v[56:59], v[248:251], v[200:203]
    ds_read_b128 v[244:247], v4 offset:34816
    v_mfma_f32_16x16x32_bf16 v[208:211], v[60:63], v[248:251], v[208:211]
    s_waitcnt lgkmcnt(8)
    v_mfma_f32_16x16x32_bf16 v[212:215], v[60:63], v[252:255], v[212:215]
    ds_read_b128 v[248:251], v4 offset:36864
    v_mfma_f32_16x16x32_bf16 v[204:207], v[56:59], v[252:255], v[204:207]
    s_waitcnt lgkmcnt(4)
    v_mfma_f32_16x16x32_bf16 v[168:171], v[64:67], v[232:235], v[168:171]
    ds_read_b128 v[252:255], v4 offset:38912
    v_mfma_f32_16x16x32_bf16 v[176:179], v[68:71], v[232:235], v[176:179]
    s_waitcnt lgkmcnt(4)
    v_mfma_f32_16x16x32_bf16 v[180:183], v[68:71], v[236:239], v[180:183]
    v_subrev_u32 v1, 57344, v1
    v_subrev_u32 v2, 57344, v2
    v_subrev_u32 v3, 57344, v3
    v_subrev_u32 v4, 57344, v4
    s_barrier
    ds_read_b64_tr_b16 v[72:73], v1 offset:0
    ds_read_b64_tr_b16 v[74:75], v1 offset:1024
    ds_read_b64_tr_b16 v[76:77], v2 offset:0
    v_mfma_f32_16x16x32_bf16 v[172:175], v[64:67], v[236:239], v[172:175]
    ds_read_b64_tr_b16 v[78:79], v2 offset:1024
    ds_read_b128 v[232:235], v3 offset:0
    s_waitcnt lgkmcnt(8)
    v_mfma_f32_16x16x32_bf16 v[184:187], v[64:67], v[240:243], v[184:187]
    ds_read_b128 v[236:239], v3 offset:2048
    v_mfma_f32_16x16x32_bf16 v[192:195], v[68:71], v[240:243], v[192:195]
    s_waitcnt lgkmcnt(8)
    v_mfma_f32_16x16x32_bf16 v[196:199], v[68:71], v[244:247], v[196:199]
    ds_read_b128 v[240:243], v3 offset:4096
    v_mfma_f32_16x16x32_bf16 v[188:191], v[64:67], v[244:247], v[188:191]
    s_waitcnt lgkmcnt(8)
    v_mfma_f32_16x16x32_bf16 v[200:203], v[64:67], v[248:251], v[200:203]
    ds_read_b128 v[244:247], v3 offset:6144
    v_mfma_f32_16x16x32_bf16 v[208:211], v[68:71], v[248:251], v[208:211]
    s_waitcnt lgkmcnt(8)
    v_mfma_f32_16x16x32_bf16 v[212:215], v[68:71], v[252:255], v[212:215]
    ds_read_b128 v[248:251], v3 offset:8192
    v_mfma_f32_16x16x32_bf16 v[204:207], v[64:67], v[252:255], v[204:207]
    s_waitcnt lgkmcnt(4)
    v_mfma_f32_16x16x32_bf16 v[168:171], v[72:75], v[232:235], v[168:171]
    ds_read_b128 v[252:255], v3 offset:10240
    v_mfma_f32_16x16x32_bf16 v[176:179], v[76:79], v[232:235], v[176:179]
    s_waitcnt lgkmcnt(4)
    v_mfma_f32_16x16x32_bf16 v[180:183], v[76:79], v[236:239], v[180:183]
    ds_read_b64_tr_b16 v[80:81], v1 offset:8192
    ds_read_b64_tr_b16 v[82:83], v1 offset:9216
    ds_read_b64_tr_b16 v[84:85], v2 offset:8192
    v_mfma_f32_16x16x32_bf16 v[172:175], v[72:75], v[236:239], v[172:175]
    ds_read_b64_tr_b16 v[86:87], v2 offset:9216
    ds_read_b128 v[232:235], v4 offset:0
    s_waitcnt lgkmcnt(8)
    v_mfma_f32_16x16x32_bf16 v[184:187], v[72:75], v[240:243], v[184:187]
    ds_read_b128 v[236:239], v4 offset:2048
    v_mfma_f32_16x16x32_bf16 v[192:195], v[76:79], v[240:243], v[192:195]
    s_waitcnt lgkmcnt(8)
    v_mfma_f32_16x16x32_bf16 v[196:199], v[76:79], v[244:247], v[196:199]
    ds_read_b128 v[240:243], v4 offset:4096
    v_mfma_f32_16x16x32_bf16 v[188:191], v[72:75], v[244:247], v[188:191]
    s_waitcnt lgkmcnt(8)
    v_mfma_f32_16x16x32_bf16 v[200:203], v[72:75], v[248:251], v[200:203]
    ds_read_b128 v[244:247], v4 offset:6144
    v_mfma_f32_16x16x32_bf16 v[208:211], v[76:79], v[248:251], v[208:211]
    s_waitcnt lgkmcnt(8)
    v_mfma_f32_16x16x32_bf16 v[212:215], v[76:79], v[252:255], v[212:215]
    ds_read_b128 v[248:251], v4 offset:8192
    v_mfma_f32_16x16x32_bf16 v[204:207], v[72:75], v[252:255], v[204:207]
    s_waitcnt lgkmcnt(4)
    v_mfma_f32_16x16x32_bf16 v[168:171], v[80:83], v[232:235], v[168:171]
    ds_read_b128 v[252:255], v4 offset:10240
    v_mfma_f32_16x16x32_bf16 v[176:179], v[84:87], v[232:235], v[176:179]
    s_waitcnt lgkmcnt(4)
    v_mfma_f32_16x16x32_bf16 v[180:183], v[84:87], v[236:239], v[180:183]
    s_barrier
    ds_read_b64_tr_b16 v[88:89], v1 offset:28672
    ds_read_b64_tr_b16 v[90:91], v1 offset:29696
    ds_read_b64_tr_b16 v[92:93], v2 offset:28672
    v_mfma_f32_16x16x32_bf16 v[172:175], v[80:83], v[236:239], v[172:175]
    ds_read_b64_tr_b16 v[94:95], v2 offset:29696
    ds_read_b128 v[232:235], v3 offset:28672
    s_waitcnt lgkmcnt(8)
    v_mfma_f32_16x16x32_bf16 v[184:187], v[80:83], v[240:243], v[184:187]
    ds_read_b128 v[236:239], v3 offset:30720
    v_mfma_f32_16x16x32_bf16 v[192:195], v[84:87], v[240:243], v[192:195]
    s_waitcnt lgkmcnt(8)
    v_mfma_f32_16x16x32_bf16 v[196:199], v[84:87], v[244:247], v[196:199]
    ds_read_b128 v[240:243], v3 offset:32768
    v_mfma_f32_16x16x32_bf16 v[188:191], v[80:83], v[244:247], v[188:191]
    s_waitcnt lgkmcnt(8)
    v_mfma_f32_16x16x32_bf16 v[200:203], v[80:83], v[248:251], v[200:203]
    ds_read_b128 v[244:247], v3 offset:34816
    v_mfma_f32_16x16x32_bf16 v[208:211], v[84:87], v[248:251], v[208:211]
    s_waitcnt lgkmcnt(8)
    v_mfma_f32_16x16x32_bf16 v[212:215], v[84:87], v[252:255], v[212:215]
    ds_read_b128 v[248:251], v3 offset:36864
    v_mfma_f32_16x16x32_bf16 v[204:207], v[80:83], v[252:255], v[204:207]
    s_waitcnt lgkmcnt(4)
    v_mfma_f32_16x16x32_bf16 v[168:171], v[88:91], v[232:235], v[168:171]
    ds_read_b128 v[252:255], v3 offset:38912
    v_mfma_f32_16x16x32_bf16 v[176:179], v[92:95], v[232:235], v[176:179]
    s_waitcnt lgkmcnt(4)
    v_mfma_f32_16x16x32_bf16 v[180:183], v[92:95], v[236:239], v[180:183]
    ds_read_b64_tr_b16 v[96:97], v1 offset:36864
    ds_read_b64_tr_b16 v[98:99], v1 offset:37888
    ds_read_b64_tr_b16 v[100:101], v2 offset:36864
    v_mfma_f32_16x16x32_bf16 v[172:175], v[88:91], v[236:239], v[172:175]
    ds_read_b64_tr_b16 v[102:103], v2 offset:37888
    ds_read_b128 v[232:235], v4 offset:28672
    s_waitcnt lgkmcnt(8)
    v_mfma_f32_16x16x32_bf16 v[184:187], v[88:91], v[240:243], v[184:187]
    ds_read_b128 v[236:239], v4 offset:30720
    v_mfma_f32_16x16x32_bf16 v[192:195], v[92:95], v[240:243], v[192:195]
    s_waitcnt lgkmcnt(8)
    v_mfma_f32_16x16x32_bf16 v[196:199], v[92:95], v[244:247], v[196:199]
    ds_read_b128 v[240:243], v4 offset:32768
    v_mfma_f32_16x16x32_bf16 v[188:191], v[88:91], v[244:247], v[188:191]
    s_waitcnt lgkmcnt(8)
    v_mfma_f32_16x16x32_bf16 v[200:203], v[88:91], v[248:251], v[200:203]
    ds_read_b128 v[244:247], v4 offset:34816
    v_mfma_f32_16x16x32_bf16 v[208:211], v[92:95], v[248:251], v[208:211]
    s_waitcnt lgkmcnt(8)
    v_mfma_f32_16x16x32_bf16 v[212:215], v[92:95], v[252:255], v[212:215]
    ds_read_b128 v[248:251], v4 offset:36864
    v_mfma_f32_16x16x32_bf16 v[204:207], v[88:91], v[252:255], v[204:207]
    s_waitcnt lgkmcnt(4)
    v_mfma_f32_16x16x32_bf16 v[168:171], v[96:99], v[232:235], v[168:171]
    ds_read_b128 v[252:255], v4 offset:38912
    v_mfma_f32_16x16x32_bf16 v[176:179], v[100:103], v[232:235], v[176:179]
    s_waitcnt lgkmcnt(4)
    v_mfma_f32_16x16x32_bf16 v[180:183], v[100:103], v[236:239], v[180:183]
    v_add_u32 v1, 57344, v1
    v_add_u32 v2, 57344, v2
    v_add_u32 v3, 57344, v3
    v_add_u32 v4, 57344, v4
    s_barrier
    ds_read_b64_tr_b16 v[104:105], v1 offset:0
    ds_read_b64_tr_b16 v[106:107], v1 offset:1024
    ds_read_b64_tr_b16 v[108:109], v2 offset:0
    v_mfma_f32_16x16x32_bf16 v[172:175], v[96:99], v[236:239], v[172:175]
    ds_read_b64_tr_b16 v[110:111], v2 offset:1024
    ds_read_b128 v[232:235], v3 offset:0
    s_waitcnt lgkmcnt(8)
    v_mfma_f32_16x16x32_bf16 v[184:187], v[96:99], v[240:243], v[184:187]
    ds_read_b128 v[236:239], v3 offset:2048
    v_mfma_f32_16x16x32_bf16 v[192:195], v[100:103], v[240:243], v[192:195]
    s_waitcnt lgkmcnt(8)
    v_mfma_f32_16x16x32_bf16 v[196:199], v[100:103], v[244:247], v[196:199]
    ds_read_b128 v[240:243], v3 offset:4096
    v_mfma_f32_16x16x32_bf16 v[188:191], v[96:99], v[244:247], v[188:191]
    s_waitcnt lgkmcnt(8)
    v_mfma_f32_16x16x32_bf16 v[200:203], v[96:99], v[248:251], v[200:203]
    ds_read_b128 v[244:247], v3 offset:6144
    v_mfma_f32_16x16x32_bf16 v[208:211], v[100:103], v[248:251], v[208:211]
    s_waitcnt lgkmcnt(8)
    v_mfma_f32_16x16x32_bf16 v[212:215], v[100:103], v[252:255], v[212:215]
    ds_read_b128 v[248:251], v3 offset:8192
    v_mfma_f32_16x16x32_bf16 v[204:207], v[96:99], v[252:255], v[204:207]
    s_waitcnt lgkmcnt(4)
    v_mfma_f32_16x16x32_bf16 v[168:171], v[104:107], v[232:235], v[168:171]
    ds_read_b128 v[252:255], v3 offset:10240
    v_mfma_f32_16x16x32_bf16 v[176:179], v[108:111], v[232:235], v[176:179]
    s_waitcnt lgkmcnt(4)
    v_mfma_f32_16x16x32_bf16 v[180:183], v[108:111], v[236:239], v[180:183]
    ds_read_b64_tr_b16 v[112:113], v1 offset:8192
    ds_read_b64_tr_b16 v[114:115], v1 offset:9216
    ds_read_b64_tr_b16 v[116:117], v2 offset:8192
    v_mfma_f32_16x16x32_bf16 v[172:175], v[104:107], v[236:239], v[172:175]
    ds_read_b64_tr_b16 v[118:119], v2 offset:9216
    ds_read_b128 v[232:235], v4 offset:0
    s_waitcnt lgkmcnt(8)
    v_mfma_f32_16x16x32_bf16 v[184:187], v[104:107], v[240:243], v[184:187]
    ds_read_b128 v[236:239], v4 offset:2048
    v_mfma_f32_16x16x32_bf16 v[192:195], v[108:111], v[240:243], v[192:195]
    s_waitcnt lgkmcnt(8)
    v_mfma_f32_16x16x32_bf16 v[196:199], v[108:111], v[244:247], v[196:199]
    ds_read_b128 v[240:243], v4 offset:4096
    v_mfma_f32_16x16x32_bf16 v[188:191], v[104:107], v[244:247], v[188:191]
    s_waitcnt lgkmcnt(8)
    v_mfma_f32_16x16x32_bf16 v[200:203], v[104:107], v[248:251], v[200:203]
    ds_read_b128 v[244:247], v4 offset:6144
    v_mfma_f32_16x16x32_bf16 v[208:211], v[108:111], v[248:251], v[208:211]
    s_waitcnt lgkmcnt(8)
    v_mfma_f32_16x16x32_bf16 v[212:215], v[108:111], v[252:255], v[212:215]
    ds_read_b128 v[248:251], v4 offset:8192
    v_mfma_f32_16x16x32_bf16 v[204:207], v[104:107], v[252:255], v[204:207]
    s_waitcnt lgkmcnt(4)
    v_mfma_f32_16x16x32_bf16 v[168:171], v[112:115], v[232:235], v[168:171]
    ds_read_b128 v[252:255], v4 offset:10240
    v_mfma_f32_16x16x32_bf16 v[176:179], v[116:119], v[232:235], v[176:179]
    s_waitcnt lgkmcnt(4)
    v_mfma_f32_16x16x32_bf16 v[180:183], v[116:119], v[236:239], v[180:183]
    s_barrier
    ds_read_b64_tr_b16 v[120:121], v1 offset:28672
    ds_read_b64_tr_b16 v[122:123], v1 offset:29696
    ds_read_b64_tr_b16 v[124:125], v2 offset:28672
    v_mfma_f32_16x16x32_bf16 v[172:175], v[112:115], v[236:239], v[172:175]
    ds_read_b64_tr_b16 v[126:127], v2 offset:29696
    ds_read_b128 v[232:235], v3 offset:28672
    s_waitcnt lgkmcnt(8)
    v_mfma_f32_16x16x32_bf16 v[184:187], v[112:115], v[240:243], v[184:187]
    ds_read_b128 v[236:239], v3 offset:30720
    v_mfma_f32_16x16x32_bf16 v[192:195], v[116:119], v[240:243], v[192:195]
    s_waitcnt lgkmcnt(8)
    v_mfma_f32_16x16x32_bf16 v[196:199], v[116:119], v[244:247], v[196:199]
    ds_read_b128 v[240:243], v3 offset:32768
    v_mfma_f32_16x16x32_bf16 v[188:191], v[112:115], v[244:247], v[188:191]
    s_waitcnt lgkmcnt(8)
    v_mfma_f32_16x16x32_bf16 v[200:203], v[112:115], v[248:251], v[200:203]
    ds_read_b128 v[244:247], v3 offset:34816
    v_mfma_f32_16x16x32_bf16 v[208:211], v[116:119], v[248:251], v[208:211]
    s_waitcnt lgkmcnt(8)
    v_mfma_f32_16x16x32_bf16 v[212:215], v[116:119], v[252:255], v[212:215]
    ds_read_b128 v[248:251], v3 offset:36864
    v_mfma_f32_16x16x32_bf16 v[204:207], v[112:115], v[252:255], v[204:207]
    s_waitcnt lgkmcnt(4)
    v_mfma_f32_16x16x32_bf16 v[168:171], v[120:123], v[232:235], v[168:171]
    ds_read_b128 v[252:255], v3 offset:38912
    v_mfma_f32_16x16x32_bf16 v[176:179], v[124:127], v[232:235], v[176:179]
    s_waitcnt lgkmcnt(4)
    v_mfma_f32_16x16x32_bf16 v[180:183], v[124:127], v[236:239], v[180:183]
    ds_read_b64_tr_b16 v[128:129], v1 offset:36864
    ds_read_b64_tr_b16 v[130:131], v1 offset:37888
    ds_read_b64_tr_b16 v[132:133], v2 offset:36864
    v_mfma_f32_16x16x32_bf16 v[172:175], v[120:123], v[236:239], v[172:175]
    ds_read_b64_tr_b16 v[134:135], v2 offset:37888
    ds_read_b128 v[232:235], v4 offset:28672
    s_waitcnt lgkmcnt(8)
    v_mfma_f32_16x16x32_bf16 v[184:187], v[120:123], v[240:243], v[184:187]
    ds_read_b128 v[236:239], v4 offset:30720
    v_mfma_f32_16x16x32_bf16 v[192:195], v[124:127], v[240:243], v[192:195]
    s_waitcnt lgkmcnt(8)
    v_mfma_f32_16x16x32_bf16 v[196:199], v[124:127], v[244:247], v[196:199]
    ds_read_b128 v[240:243], v4 offset:32768
    v_mfma_f32_16x16x32_bf16 v[188:191], v[120:123], v[244:247], v[188:191]
    s_waitcnt lgkmcnt(8)
    v_mfma_f32_16x16x32_bf16 v[200:203], v[120:123], v[248:251], v[200:203]
    ds_read_b128 v[244:247], v4 offset:34816
    v_mfma_f32_16x16x32_bf16 v[208:211], v[124:127], v[248:251], v[208:211]
    s_waitcnt lgkmcnt(8)
    v_mfma_f32_16x16x32_bf16 v[212:215], v[124:127], v[252:255], v[212:215]
    ds_read_b128 v[248:251], v4 offset:36864
    v_mfma_f32_16x16x32_bf16 v[204:207], v[120:123], v[252:255], v[204:207]
    s_waitcnt lgkmcnt(4)
    v_mfma_f32_16x16x32_bf16 v[168:171], v[128:131], v[232:235], v[168:171]
    ds_read_b128 v[252:255], v4 offset:38912
    v_mfma_f32_16x16x32_bf16 v[176:179], v[132:135], v[232:235], v[176:179]
    s_waitcnt lgkmcnt(4)
    v_mfma_f32_16x16x32_bf16 v[180:183], v[132:135], v[236:239], v[180:183]
    v_subrev_u32 v1, 57344, v1
    v_subrev_u32 v2, 57344, v2
    v_subrev_u32 v3, 57344, v3
    v_subrev_u32 v4, 57344, v4
    s_barrier
    ds_read_b64_tr_b16 v[136:137], v1 offset:0
    ds_read_b64_tr_b16 v[138:139], v1 offset:1024
    ds_read_b64_tr_b16 v[140:141], v2 offset:0
    v_mfma_f32_16x16x32_bf16 v[172:175], v[128:131], v[236:239], v[172:175]
    ds_read_b64_tr_b16 v[142:143], v2 offset:1024
    ds_read_b128 v[232:235], v3 offset:0
    s_waitcnt lgkmcnt(8)
    v_mfma_f32_16x16x32_bf16 v[184:187], v[128:131], v[240:243], v[184:187]
    ds_read_b128 v[236:239], v3 offset:2048
    v_mfma_f32_16x16x32_bf16 v[192:195], v[132:135], v[240:243], v[192:195]
    s_waitcnt lgkmcnt(8)
    v_mfma_f32_16x16x32_bf16 v[196:199], v[132:135], v[244:247], v[196:199]
    ds_read_b128 v[240:243], v3 offset:4096
    v_mfma_f32_16x16x32_bf16 v[188:191], v[128:131], v[244:247], v[188:191]
    s_waitcnt lgkmcnt(8)
    v_mfma_f32_16x16x32_bf16 v[200:203], v[128:131], v[248:251], v[200:203]
    ds_read_b128 v[244:247], v3 offset:6144
    v_mfma_f32_16x16x32_bf16 v[208:211], v[132:135], v[248:251], v[208:211]
    s_waitcnt lgkmcnt(8)
    v_mfma_f32_16x16x32_bf16 v[212:215], v[132:135], v[252:255], v[212:215]
    ds_read_b128 v[248:251], v3 offset:8192
    v_mfma_f32_16x16x32_bf16 v[204:207], v[128:131], v[252:255], v[204:207]
    s_waitcnt lgkmcnt(4)
    v_mfma_f32_16x16x32_bf16 v[168:171], v[136:139], v[232:235], v[168:171]
    ds_read_b128 v[252:255], v3 offset:10240
    v_mfma_f32_16x16x32_bf16 v[176:179], v[140:143], v[232:235], v[176:179]
    s_waitcnt lgkmcnt(4)
    v_mfma_f32_16x16x32_bf16 v[180:183], v[140:143], v[236:239], v[180:183]
    ds_read_b64_tr_b16 v[144:145], v1 offset:8192
    ds_read_b64_tr_b16 v[146:147], v1 offset:9216
    ds_read_b64_tr_b16 v[148:149], v2 offset:8192
    v_mfma_f32_16x16x32_bf16 v[172:175], v[136:139], v[236:239], v[172:175]
    ds_read_b64_tr_b16 v[150:151], v2 offset:9216
    ds_read_b128 v[232:235], v4 offset:0
    s_waitcnt lgkmcnt(8)
    v_mfma_f32_16x16x32_bf16 v[184:187], v[136:139], v[240:243], v[184:187]
    ds_read_b128 v[236:239], v4 offset:2048
    v_mfma_f32_16x16x32_bf16 v[192:195], v[140:143], v[240:243], v[192:195]
    s_waitcnt lgkmcnt(8)
    v_mfma_f32_16x16x32_bf16 v[196:199], v[140:143], v[244:247], v[196:199]
    ds_read_b128 v[240:243], v4 offset:4096
    v_mfma_f32_16x16x32_bf16 v[188:191], v[136:139], v[244:247], v[188:191]
    s_waitcnt lgkmcnt(8)
    v_mfma_f32_16x16x32_bf16 v[200:203], v[136:139], v[248:251], v[200:203]
    ds_read_b128 v[244:247], v4 offset:6144
    v_mfma_f32_16x16x32_bf16 v[208:211], v[140:143], v[248:251], v[208:211]
    s_waitcnt lgkmcnt(8)
    v_mfma_f32_16x16x32_bf16 v[212:215], v[140:143], v[252:255], v[212:215]
    ds_read_b128 v[248:251], v4 offset:8192
    v_mfma_f32_16x16x32_bf16 v[204:207], v[136:139], v[252:255], v[204:207]
    s_waitcnt lgkmcnt(4)
    v_mfma_f32_16x16x32_bf16 v[168:171], v[144:147], v[232:235], v[168:171]
    ds_read_b128 v[252:255], v4 offset:10240
    v_mfma_f32_16x16x32_bf16 v[176:179], v[148:151], v[232:235], v[176:179]
    s_waitcnt lgkmcnt(4)
    v_mfma_f32_16x16x32_bf16 v[180:183], v[148:151], v[236:239], v[180:183]
    s_barrier
    ds_read_b64_tr_b16 v[152:153], v1 offset:28672
    ds_read_b64_tr_b16 v[154:155], v1 offset:29696
    ds_read_b64_tr_b16 v[156:157], v2 offset:28672
    v_mfma_f32_16x16x32_bf16 v[172:175], v[144:147], v[236:239], v[172:175]
    ds_read_b64_tr_b16 v[158:159], v2 offset:29696
    ds_read_b128 v[232:235], v3 offset:28672
    s_waitcnt lgkmcnt(8)
    v_mfma_f32_16x16x32_bf16 v[184:187], v[144:147], v[240:243], v[184:187]
    ds_read_b128 v[236:239], v3 offset:30720
    v_mfma_f32_16x16x32_bf16 v[192:195], v[148:151], v[240:243], v[192:195]
    s_waitcnt lgkmcnt(8)
    v_mfma_f32_16x16x32_bf16 v[196:199], v[148:151], v[244:247], v[196:199]
    ds_read_b128 v[240:243], v3 offset:32768
    v_mfma_f32_16x16x32_bf16 v[188:191], v[144:147], v[244:247], v[188:191]
    s_waitcnt lgkmcnt(8)
    v_mfma_f32_16x16x32_bf16 v[200:203], v[144:147], v[248:251], v[200:203]
    ds_read_b128 v[244:247], v3 offset:34816
    v_mfma_f32_16x16x32_bf16 v[208:211], v[148:151], v[248:251], v[208:211]
    s_waitcnt lgkmcnt(8)
    v_mfma_f32_16x16x32_bf16 v[212:215], v[148:151], v[252:255], v[212:215]
    ds_read_b128 v[248:251], v3 offset:36864
    v_mfma_f32_16x16x32_bf16 v[204:207], v[144:147], v[252:255], v[204:207]
    s_waitcnt lgkmcnt(4)
    v_mfma_f32_16x16x32_bf16 v[168:171], v[152:155], v[232:235], v[168:171]
    ds_read_b128 v[252:255], v3 offset:38912
    v_mfma_f32_16x16x32_bf16 v[176:179], v[156:159], v[232:235], v[176:179]
    s_waitcnt lgkmcnt(4)
    v_mfma_f32_16x16x32_bf16 v[180:183], v[156:159], v[236:239], v[180:183]
    ds_read_b64_tr_b16 v[160:161], v1 offset:36864
    ds_read_b64_tr_b16 v[162:163], v1 offset:37888
    ds_read_b64_tr_b16 v[164:165], v2 offset:36864
    v_mfma_f32_16x16x32_bf16 v[172:175], v[152:155], v[236:239], v[172:175]
    ds_read_b64_tr_b16 v[166:167], v2 offset:37888
    ds_read_b128 v[232:235], v4 offset:28672
    s_waitcnt lgkmcnt(8)
    v_mfma_f32_16x16x32_bf16 v[184:187], v[152:155], v[240:243], v[184:187]
    ds_read_b128 v[236:239], v4 offset:30720
    v_mfma_f32_16x16x32_bf16 v[192:195], v[156:159], v[240:243], v[192:195]
    s_waitcnt lgkmcnt(8)
    v_mfma_f32_16x16x32_bf16 v[196:199], v[156:159], v[244:247], v[196:199]
    ds_read_b128 v[240:243], v4 offset:32768
    v_mfma_f32_16x16x32_bf16 v[188:191], v[152:155], v[244:247], v[188:191]
    s_waitcnt lgkmcnt(8)
    v_mfma_f32_16x16x32_bf16 v[200:203], v[152:155], v[248:251], v[200:203]
    ds_read_b128 v[244:247], v4 offset:34816
    v_mfma_f32_16x16x32_bf16 v[208:211], v[156:159], v[248:251], v[208:211]
    s_waitcnt lgkmcnt(8)
    v_mfma_f32_16x16x32_bf16 v[212:215], v[156:159], v[252:255], v[212:215]
    ds_read_b128 v[248:251], v4 offset:36864
    v_mfma_f32_16x16x32_bf16 v[204:207], v[152:155], v[252:255], v[204:207]
    s_waitcnt lgkmcnt(4)
    v_mfma_f32_16x16x32_bf16 v[168:171], v[160:163], v[232:235], v[168:171]
    ds_read_b128 v[252:255], v4 offset:38912
    v_mfma_f32_16x16x32_bf16 v[176:179], v[164:167], v[232:235], v[176:179]
    s_waitcnt lgkmcnt(4)
    v_mfma_f32_16x16x32_bf16 v[180:183], v[164:167], v[236:239], v[180:183]
    v_add_u32 v3, s14, v3
    v_add_u32 v4, s14, v4
    s_barrier
    ds_read_b128 v[232:235], v3 offset:0
    v_mfma_f32_16x16x32_bf16 v[172:175], v[160:163], v[236:239], v[172:175]
    s_waitcnt lgkmcnt(4)
    v_mfma_f32_16x16x32_bf16 v[184:187], v[160:163], v[240:243], v[184:187]
    ds_read_b128 v[236:239], v3 offset:2048
    v_mfma_f32_16x16x32_bf16 v[192:195], v[164:167], v[240:243], v[192:195]
    s_waitcnt lgkmcnt(4)
    v_mfma_f32_16x16x32_bf16 v[196:199], v[164:167], v[244:247], v[196:199]
    ds_read_b128 v[240:243], v4 offset:0
    v_mfma_f32_16x16x32_bf16 v[188:191], v[160:163], v[244:247], v[188:191]
    s_waitcnt lgkmcnt(4)
    v_mfma_f32_16x16x32_bf16 v[200:203], v[160:163], v[248:251], v[200:203]
    ds_read_b128 v[244:247], v4 offset:2048
    v_mfma_f32_16x16x32_bf16 v[208:211], v[164:167], v[248:251], v[208:211]
    s_waitcnt lgkmcnt(4)
    v_mfma_f32_16x16x32_bf16 v[212:215], v[164:167], v[252:255], v[212:215]
    ds_read_b128 v[248:251], v3 offset:4096
    v_mfma_f32_16x16x32_bf16 v[204:207], v[160:163], v[252:255], v[204:207]
    s_waitcnt lgkmcnt(3)
    v_mfma_f32_16x16x32_bf16 v[216:219], v[8:11], v[232:235], 0
    ds_read_b128 v[252:255], v3 offset:6144
    v_mfma_f32_16x16x32_bf16 v[224:227], v[12:15], v[232:235], 0
    v_mfma_f32_16x16x32_bf16 v[228:231], v[12:15], v[236:239], 0
    ds_read_b128 v[232:235], v4 offset:4096
    v_pk_mul_f32 v[168:169], v[168:169], s[10:11] op_sel_hi:[1,0]
    v_mfma_f32_16x16x32_bf16 v[220:223], v[8:11], v[236:239], 0
    v_pk_mul_f32 v[170:171], v[170:171], s[10:11] op_sel_hi:[1,0]
    v_pk_mul_f32 v[172:173], v[172:173], s[10:11] op_sel_hi:[1,0]
    s_waitcnt lgkmcnt(3)
    v_mfma_f32_16x16x32_bf16 v[216:219], v[16:19], v[240:243], v[216:219]
    ds_read_b128 v[236:239], v4 offset:6144
    v_pk_mul_f32 v[174:175], v[174:175], s[10:11] op_sel_hi:[1,0]
    v_mfma_f32_16x16x32_bf16 v[224:227], v[20:23], v[240:243], v[224:227]
    v_pk_mul_f32 v[176:177], v[176:177], s[10:11] op_sel_hi:[1,0]
    v_pk_mul_f32 v[178:179], v[178:179], s[10:11] op_sel_hi:[1,0]
    v_mfma_f32_16x16x32_bf16 v[228:231], v[20:23], v[244:247], v[228:231]
    ds_read_b128 v[240:243], v3 offset:8192
    v_pk_mul_f32 v[180:181], v[180:181], s[10:11] op_sel_hi:[1,0]
    v_mfma_f32_16x16x32_bf16 v[220:223], v[16:19], v[244:247], v[220:223]
    v_pk_mul_f32 v[182:183], v[182:183], s[10:11] op_sel_hi:[1,0]
    v_cvt_pk_bf16_f32 v168, v168, v169
    s_waitcnt lgkmcnt(3)
    v_mfma_f32_16x16x32_bf16 v[216:219], v[24:27], v[248:251], v[216:219]
    ds_read_b128 v[244:247], v3 offset:10240
    v_cvt_pk_bf16_f32 v169, v170, v171
    v_mfma_f32_16x16x32_bf16 v[224:227], v[28:31], v[248:251], v[224:227]
    v_cvt_pk_bf16_f32 v170, v172, v173
    v_cvt_pk_bf16_f32 v171, v174, v175
    v_mfma_f32_16x16x32_bf16 v[228:231], v[28:31], v[252:255], v[228:231]
    ds_read_b128 v[248:251], v4 offset:8192
    v_cvt_pk_bf16_f32 v172, v176, v177
    v_mfma_f32_16x16x32_bf16 v[220:223], v[24:27], v[252:255], v[220:223]
    v_cvt_pk_bf16_f32 v173, v178, v179
    v_cvt_pk_bf16_f32 v174, v180, v181
    s_waitcnt lgkmcnt(3)
    v_mfma_f32_16x16x32_bf16 v[216:219], v[32:35], v[232:235], v[216:219]
    ds_read_b128 v[252:255], v4 offset:10240
    v_cvt_pk_bf16_f32 v175, v182, v183
    v_mfma_f32_16x16x32_bf16 v[224:227], v[36:39], v[232:235], v[224:227]
    v_permlane16_swap_b32 v168, v170
    v_permlane16_swap_b32 v169, v171
    v_mfma_f32_16x16x32_bf16 v[228:231], v[36:39], v[236:239], v[228:231]
    ds_read_b128 v[232:235], v3 offset:12288
    v_permlane16_swap_b32 v172, v174
    v_mfma_f32_16x16x32_bf16 v[220:223], v[32:35], v[236:239], v[220:223]
    v_permlane16_swap_b32 v173, v175
    v_pk_mul_f32 v[184:185], v[184:185], s[10:11] op_sel_hi:[1,0]
    s_waitcnt lgkmcnt(3)
    v_mfma_f32_16x16x32_bf16 v[216:219], v[40:43], v[240:243], v[216:219]
    ds_read_b128 v[236:239], v3 offset:14336
    v_pk_mul_f32 v[186:187], v[186:187], s[10:11] op_sel_hi:[1,0]
    v_mfma_f32_16x16x32_bf16 v[224:227], v[44:47], v[240:243], v[224:227]
    buffer_store_dwordx4 v[168:171], v6, s[48:51], 0 offen offset:0 sc1
    v_pk_mul_f32 v[188:189], v[188:189], s[10:11] op_sel_hi:[1,0]
    v_pk_mul_f32 v[190:191], v[190:191], s[10:11] op_sel_hi:[1,0]
    v_mfma_f32_16x16x32_bf16 v[228:231], v[44:47], v[244:247], v[228:231]
    ds_read_b128 v[240:243], v4 offset:12288
    v_pk_mul_f32 v[192:193], v[192:193], s[10:11] op_sel_hi:[1,0]
    v_mfma_f32_16x16x32_bf16 v[220:223], v[40:43], v[244:247], v[220:223]
    v_pk_mul_f32 v[194:195], v[194:195], s[10:11] op_sel_hi:[1,0]
    v_pk_mul_f32 v[196:197], v[196:197], s[10:11] op_sel_hi:[1,0]
    s_waitcnt lgkmcnt(3)
    v_mfma_f32_16x16x32_bf16 v[216:219], v[48:51], v[248:251], v[216:219]
    ds_read_b128 v[244:247], v4 offset:14336
    v_pk_mul_f32 v[198:199], v[198:199], s[10:11] op_sel_hi:[1,0]
    v_mfma_f32_16x16x32_bf16 v[224:227], v[52:55], v[248:251], v[224:227]
    v_cvt_pk_bf16_f32 v184, v184, v185
    v_cvt_pk_bf16_f32 v185, v186, v187
    v_mfma_f32_16x16x32_bf16 v[228:231], v[52:55], v[252:255], v[228:231]
    ds_read_b128 v[248:251], v3 offset:16384
    v_cvt_pk_bf16_f32 v186, v188, v189
    v_mfma_f32_16x16x32_bf16 v[220:223], v[48:51], v[252:255], v[220:223]
    v_cvt_pk_bf16_f32 v187, v190, v191
    v_cvt_pk_bf16_f32 v188, v192, v193
    s_waitcnt lgkmcnt(3)
    v_mfma_f32_16x16x32_bf16 v[216:219], v[56:59], v[232:235], v[216:219]
    ds_read_b128 v[252:255], v3 offset:18432
    v_cvt_pk_bf16_f32 v189, v194, v195
    v_mfma_f32_16x16x32_bf16 v[224:227], v[60:63], v[232:235], v[224:227]
    buffer_store_dwordx4 v[172:175], v6, s[48:51], s11 offen offset:0 sc1
    v_cvt_pk_bf16_f32 v190, v196, v197
    v_cvt_pk_bf16_f32 v191, v198, v199
    v_mfma_f32_16x16x32_bf16 v[228:231], v[60:63], v[236:239], v[228:231]
    ds_read_b128 v[232:235], v4 offset:16384
    v_permlane16_swap_b32 v184, v186
    v_mfma_f32_16x16x32_bf16 v[220:223], v[56:59], v[236:239], v[220:223]
    v_permlane16_swap_b32 v185, v187
    v_permlane16_swap_b32 v188, v190
    s_waitcnt lgkmcnt(3)
    v_mfma_f32_16x16x32_bf16 v[216:219], v[64:67], v[240:243], v[216:219]
    ds_read_b128 v[236:239], v4 offset:18432
    v_permlane16_swap_b32 v189, v191
    v_mfma_f32_16x16x32_bf16 v[224:227], v[68:71], v[240:243], v[224:227]
    v_pk_mul_f32 v[200:201], v[200:201], s[10:11] op_sel_hi:[1,0]
    v_pk_mul_f32 v[202:203], v[202:203], s[10:11] op_sel_hi:[1,0]
    v_mfma_f32_16x16x32_bf16 v[228:231], v[68:71], v[244:247], v[228:231]
    s_barrier
    ds_read_b128 v[240:243], v3 offset:20480
    v_pk_mul_f32 v[204:205], v[204:205], s[10:11] op_sel_hi:[1,0]
    v_mfma_f32_16x16x32_bf16 v[220:223], v[64:67], v[244:247], v[220:223]
    v_pk_mul_f32 v[206:207], v[206:207], s[10:11] op_sel_hi:[1,0]
    v_pk_mul_f32 v[208:209], v[208:209], s[10:11] op_sel_hi:[1,0]
    s_waitcnt lgkmcnt(3)
    v_mfma_f32_16x16x32_bf16 v[216:219], v[72:75], v[248:251], v[216:219]
    ds_read_b128 v[244:247], v3 offset:22528
    v_pk_mul_f32 v[210:211], v[210:211], s[10:11] op_sel_hi:[1,0]
    v_mfma_f32_16x16x32_bf16 v[224:227], v[76:79], v[248:251], v[224:227]
    buffer_store_dwordx4 v[184:187], v6, s[48:51], 0 offen offset:512 sc1
    v_pk_mul_f32 v[212:213], v[212:213], s[10:11] op_sel_hi:[1,0]
    v_pk_mul_f32 v[214:215], v[214:215], s[10:11] op_sel_hi:[1,0]
    v_mfma_f32_16x16x32_bf16 v[228:231], v[76:79], v[252:255], v[228:231]
    ds_read_b128 v[248:251], v4 offset:20480
    v_cvt_pk_bf16_f32 v200, v200, v201
    v_mfma_f32_16x16x32_bf16 v[220:223], v[72:75], v[252:255], v[220:223]
    v_cvt_pk_bf16_f32 v201, v202, v203
    v_cvt_pk_bf16_f32 v202, v204, v205
    s_waitcnt lgkmcnt(3)
    v_mfma_f32_16x16x32_bf16 v[216:219], v[80:83], v[232:235], v[216:219]
    ds_read_b128 v[252:255], v4 offset:22528
    v_cvt_pk_bf16_f32 v203, v206, v207
    v_mfma_f32_16x16x32_bf16 v[224:227], v[84:87], v[232:235], v[224:227]
    v_cvt_pk_bf16_f32 v204, v208, v209
    v_cvt_pk_bf16_f32 v205, v210, v211
    v_mfma_f32_16x16x32_bf16 v[228:231], v[84:87], v[236:239], v[228:231]
    ds_read_b128 v[232:235], v3 offset:24576
    v_cvt_pk_bf16_f32 v206, v212, v213
    v_mfma_f32_16x16x32_bf16 v[220:223], v[80:83], v[236:239], v[220:223]
    v_cvt_pk_bf16_f32 v207, v214, v215
    v_permlane16_swap_b32 v200, v202
    s_load_dwordx2 s[64:65], s[36:37], 0
    s_waitcnt lgkmcnt(3)
    v_mfma_f32_16x16x32_bf16 v[216:219], v[88:91], v[240:243], v[216:219]
    ds_read_b128 v[236:239], v3 offset:26624
    v_permlane16_swap_b32 v201, v203
    v_mfma_f32_16x16x32_bf16 v[224:227], v[92:95], v[240:243], v[224:227]
    buffer_store_dwordx4 v[188:191], v6, s[48:51], s11 offen offset:512 sc1
    v_permlane16_swap_b32 v204, v206
    v_permlane16_swap_b32 v205, v207
    v_mfma_f32_16x16x32_bf16 v[228:231], v[92:95], v[244:247], v[228:231]
    ds_read_b128 v[240:243], v4 offset:24576
    v_mfma_f32_16x16x32_bf16 v[220:223], v[88:91], v[244:247], v[220:223]
    s_waitcnt lgkmcnt(3)
    v_mfma_f32_16x16x32_bf16 v[216:219], v[96:99], v[248:251], v[216:219]
    ds_read_b128 v[244:247], v4 offset:26624
    v_mfma_f32_16x16x32_bf16 v[224:227], v[100:103], v[248:251], v[224:227]
    v_mfma_f32_16x16x32_bf16 v[228:231], v[100:103], v[252:255], v[228:231]
    ds_read_b128 v[248:251], v3 offset:28672
    v_mfma_f32_16x16x32_bf16 v[220:223], v[96:99], v[252:255], v[220:223]
    s_waitcnt lgkmcnt(3)
    v_mfma_f32_16x16x32_bf16 v[216:219], v[104:107], v[232:235], v[216:219]
    ds_read_b128 v[252:255], v3 offset:30720
    v_mfma_f32_16x16x32_bf16 v[224:227], v[108:111], v[232:235], v[224:227]
    buffer_store_dwordx4 v[200:203], v6, s[48:51], 0 offen offset:1024 sc1
    v_mfma_f32_16x16x32_bf16 v[228:231], v[108:111], v[236:239], v[228:231]
    ds_read_b128 v[232:235], v4 offset:28672
    v_mfma_f32_16x16x32_bf16 v[220:223], v[104:107], v[236:239], v[220:223]
    s_waitcnt lgkmcnt(3)
    v_mfma_f32_16x16x32_bf16 v[216:219], v[112:115], v[240:243], v[216:219]
    ds_read_b128 v[236:239], v4 offset:30720
    v_mfma_f32_16x16x32_bf16 v[224:227], v[116:119], v[240:243], v[224:227]
    v_mfma_f32_16x16x32_bf16 v[228:231], v[116:119], v[244:247], v[228:231]
    ds_read_b128 v[240:243], v3 offset:32768
    v_mfma_f32_16x16x32_bf16 v[220:223], v[112:115], v[244:247], v[220:223]
    s_waitcnt lgkmcnt(3)
    v_mfma_f32_16x16x32_bf16 v[216:219], v[120:123], v[248:251], v[216:219]
    ds_read_b128 v[244:247], v3 offset:34816
    v_mfma_f32_16x16x32_bf16 v[224:227], v[124:127], v[248:251], v[224:227]
    buffer_store_dwordx4 v[204:207], v6, s[48:51], s11 offen offset:1024 sc1
    v_mfma_f32_16x16x32_bf16 v[228:231], v[124:127], v[252:255], v[228:231]
    ds_read_b128 v[248:251], v4 offset:32768
    v_mfma_f32_16x16x32_bf16 v[220:223], v[120:123], v[252:255], v[220:223]
    s_waitcnt lgkmcnt(3)
    v_mfma_f32_16x16x32_bf16 v[216:219], v[128:131], v[232:235], v[216:219]
    ds_read_b128 v[252:255], v4 offset:34816
    v_mfma_f32_16x16x32_bf16 v[224:227], v[132:135], v[232:235], v[224:227]
    v_mfma_f32_16x16x32_bf16 v[228:231], v[132:135], v[236:239], v[228:231]
    ds_read_b128 v[232:235], v3 offset:36864
    v_mfma_f32_16x16x32_bf16 v[220:223], v[128:131], v[236:239], v[220:223]
    s_waitcnt lgkmcnt(3)
    v_mfma_f32_16x16x32_bf16 v[216:219], v[136:139], v[240:243], v[216:219]
    ds_read_b128 v[236:239], v3 offset:38912
    v_mfma_f32_16x16x32_bf16 v[224:227], v[140:143], v[240:243], v[224:227]
    v_mfma_f32_16x16x32_bf16 v[228:231], v[140:143], v[244:247], v[228:231]
    ds_read_b128 v[240:243], v4 offset:36864
    v_mfma_f32_16x16x32_bf16 v[220:223], v[136:139], v[244:247], v[220:223]
    s_waitcnt lgkmcnt(3)
    v_mfma_f32_16x16x32_bf16 v[216:219], v[144:147], v[248:251], v[216:219]
    ds_read_b128 v[244:247], v4 offset:38912
    v_mfma_f32_16x16x32_bf16 v[224:227], v[148:151], v[248:251], v[224:227]
    s_cmp_eq_u32 s6, 12
    s_cbranch_scc1 .La_light
    v_mfma_f32_16x16x32_bf16 v[228:231], v[148:151], v[252:255], v[228:231]
    v_subrev_u32 v3, 57344, v3
    v_subrev_u32 v4, 57344, v4
    s_waitcnt lgkmcnt(0)
    s_waitcnt lgkmcnt(0)
    s_cmp_lg_u32 s65, 0
    s_cbranch_scc1 .Ltagd_27
    v_mov_b32 v194, 0
    s_mov_b32 s74, 16384
.Ltag_26:
    global_load_dwordx2 v[192:193], v194, s[36:37] sc1
    s_waitcnt vmcnt(0)
    v_readfirstlane_b32 s64, v192
    v_readfirstlane_b32 s65, v193
    s_nop 0
    s_cmp_lg_u32 s65, 0
    s_cbranch_scc1 .Ltagd_27
    s_sub_u32 s74, s74, 1
    s_cbranch_scc0 .Ltag_26
.Ltagd_27:
    s_barrier
    ds_read_b128 v[248:251], v3 offset:0
    v_mfma_f32_16x16x32_bf16 v[220:223], v[144:147], v[252:255], v[220:223]
    v_mfma_f32_16x16x32_bf16 v[216:219], v[152:155], v[232:235], v[216:219]
    ds_read_b128 v[252:255], v3 offset:2048
    v_mfma_f32_16x16x32_bf16 v[224:227], v[156:159], v[232:235], v[224:227]
    v_mfma_f32_16x16x32_bf16 v[228:231], v[156:159], v[236:239], v[228:231]
    ds_read_b128 v[232:235], v4 offset:0
    v_mfma_f32_16x16x32_bf16 v[220:223], v[152:155], v[236:239], v[220:223]
    v_mfma_f32_16x16x32_bf16 v[216:219], v[160:163], v[240:243], v[216:219]
    ds_read_b128 v[236:239], v4 offset:2048
    v_mfma_f32_16x16x32_bf16 v[224:227], v[164:167], v[240:243], v[224:227]
    v_mfma_f32_16x16x32_bf16 v[228:231], v[164:167], v[244:247], v[228:231]
    ds_read_b128 v[240:243], v3 offset:4096
    v_mfma_f32_16x16x32_bf16 v[220:223], v[160:163], v[244:247], v[220:223]
    s_waitcnt lgkmcnt(3)
    v_mfma_f32_16x16x32_bf16 v[168:171], v[8:11], v[248:251], 0
    ds_read_b128 v[244:247], v3 offset:6144
    v_mfma_f32_16x16x32_bf16 v[176:179], v[12:15], v[248:251], 0
    v_mfma_f32_16x16x32_bf16 v[180:183], v[12:15], v[252:255], 0
    ds_read_b128 v[248:251], v4 offset:4096
    v_mfma_f32_16x16x32_bf16 v[172:175], v[8:11], v[252:255], 0
    s_waitcnt lgkmcnt(3)
    v_mfma_f32_16x16x32_bf16 v[168:171], v[16:19], v[232:235], v[168:171]
    ds_read_b128 v[252:255], v4 offset:6144
    v_pk_mul_f32 v[216:217], v[216:217], s[10:11] op_sel_hi:[1,0]
    v_mfma_f32_16x16x32_bf16 v[176:179], v[20:23], v[232:235], v[176:179]
    v_pk_mul_f32 v[218:219], v[218:219], s[10:11] op_sel_hi:[1,0]
    v_pk_mul_f32 v[220:221], v[220:221], s[10:11] op_sel_hi:[1,0]
    v_mfma_f32_16x16x32_bf16 v[180:183], v[20:23], v[236:239], v[180:183]
    ds_read_b128 v[232:235], v3 offset:8192
    v_pk_mul_f32 v[222:223], v[222:223], s[10:11] op_sel_hi:[1,0]
    v_mfma_f32_16x16x32_bf16 v[172:175], v[16:19], v[236:239], v[172:175]
    v_pk_mul_f32 v[224:225], v[224:225], s[10:11] op_sel_hi:[1,0]
    v_pk_mul_f32 v[226:227], v[226:227], s[10:11] op_sel_hi:[1,0]
    s_waitcnt lgkmcnt(3)
    v_mfma_f32_16x16x32_bf16 v[168:171], v[24:27], v[240:243], v[168:171]
    ds_read_b128 v[236:239], v3 offset:10240
    v_pk_mul_f32 v[228:229], v[228:229], s[10:11] op_sel_hi:[1,0]
    v_mfma_f32_16x16x32_bf16 v[176:179], v[28:31], v[240:243], v[176:179]
    v_pk_mul_f32 v[230:231], v[230:231], s[10:11] op_sel_hi:[1,0]
    v_cvt_pk_bf16_f32 v216, v216, v217
    v_mfma_f32_16x16x32_bf16 v[180:183], v[28:31], v[244:247], v[180:183]
    ds_read_b128 v[240:243], v4 offset:8192
    v_cvt_pk_bf16_f32 v217, v218, v219
    v_mfma_f32_16x16x32_bf16 v[172:175], v[24:27], v[244:247], v[172:175]
    v_cvt_pk_bf16_f32 v218, v220, v221
    v_cvt_pk_bf16_f32 v219, v222, v223
    s_waitcnt lgkmcnt(3)
    v_mfma_f32_16x16x32_bf16 v[168:171], v[32:35], v[248:251], v[168:171]
    ds_read_b128 v[244:247], v4 offset:10240
    v_cvt_pk_bf16_f32 v220, v224, v225
    v_mfma_f32_16x16x32_bf16 v[176:179], v[36:39], v[248:251], v[176:179]
    v_cvt_pk_bf16_f32 v221, v226, v227
    v_cvt_pk_bf16_f32 v222, v228, v229
    v_mfma_f32_16x16x32_bf16 v[180:183], v[36:39], v[252:255], v[180:183]
    ds_read_b128 v[248:251], v3 offset:12288
    v_cvt_pk_bf16_f32 v223, v230, v231
    v_mfma_f32_16x16x32_bf16 v[172:175], v[32:35], v[252:255], v[172:175]
    v_permlane16_swap_b32 v216, v218
    v_permlane16_swap_b32 v217, v219
    s_waitcnt lgkmcnt(3)
    v_mfma_f32_16x16x32_bf16 v[168:171], v[40:43], v[232:235], v[168:171]
    ds_read_b128 v[252:255], v3 offset:14336
    v_permlane16_swap_b32 v220, v222
    v_mfma_f32_16x16x32_bf16 v[176:179], v[44:47], v[232:235], v[176:179]
    v_permlane16_swap_b32 v221, v223
    v_mfma_f32_16x16x32_bf16 v[180:183], v[44:47], v[236:239], v[180:183]
    ds_read_b128 v[232:235], v4 offset:12288
    v_mfma_f32_16x16x32_bf16 v[172:175], v[40:43], v[236:239], v[172:175]
    buffer_store_dwordx4 v[216:219], v6, s[48:51], 0 offen offset:1536 sc1
    s_waitcnt lgkmcnt(3)
    v_mfma_f32_16x16x32_bf16 v[168:171], v[48:51], v[240:243], v[168:171]
    ds_read_b128 v[236:239], v4 offset:14336
    v_mfma_f32_16x16x32_bf16 v[176:179], v[52:55], v[240:243], v[176:179]
    v_mfma_f32_16x16x32_bf16 v[180:183], v[52:55], v[244:247], v[180:183]
    ds_read_b128 v[240:243], v3 offset:16384
    v_mfma_f32_16x16x32_bf16 v[172:175], v[48:51], v[244:247], v[172:175]
    s_waitcnt lgkmcnt(3)
    v_mfma_f32_16x16x32_bf16 v[168:171], v[56:59], v[248:251], v[168:171]
    ds_read_b128 v[244:247], v3 offset:18432
    v_mfma_f32_16x16x32_bf16 v[176:179], v[60:63], v[248:251], v[176:179]
    v_mfma_f32_16x16x32_bf16 v[180:183], v[60:63], v[252:255], v[180:183]
    ds_read_b128 v[248:251], v4 offset:16384
    v_mfma_f32_16x16x32_bf16 v[172:175], v[56:59], v[252:255], v[172:175]
    buffer_store_dwordx4 v[220:223], v6, s[48:51], s11 offen offset:1536 sc1
    s_waitcnt lgkmcnt(3)
    v_mfma_f32_16x16x32_bf16 v[168:171], v[64:67], v[232:235], v[168:171]
    ds_read_b128 v[252:255], v4 offset:18432
    v_mfma_f32_16x16x32_bf16 v[176:179], v[68:71], v[232:235], v[176:179]
    v_mfma_f32_16x16x32_bf16 v[180:183], v[68:71], v[236:239], v[180:183]
    ds_read_b128 v[232:235], v3 offset:20480
    v_mfma_f32_16x16x32_bf16 v[172:175], v[64:67], v[236:239], v[172:175]
    s_waitcnt vmcnt(2)
    v_mov_b32 v192, s64
    v_mov_b32 v193, s65
    v_mov_b32 v194, 0
    v_mov_b32 v195, 0
    v_lshlrev_b32 v196, 4, v0
    s_mov_b64 exec, 0xff
    buffer_store_dwordx4 v[192:195], v196, s[48:51], s13 offen sc1
    s_mov_b64 exec, -1
    s_waitcnt lgkmcnt(3)
    v_mfma_f32_16x16x32_bf16 v[168:171], v[72:75], v[240:243], v[168:171]
    ds_read_b128 v[236:239], v3 offset:22528
    s_mul_i32 s57, s5, 5
    v_mfma_f32_16x16x32_bf16 v[176:179], v[76:79], v[240:243], v[176:179]
    s_lshr_b32 s57, s57, 1
    s_and_b32 s58, s5, 1
    v_mfma_f32_16x16x32_bf16 v[180:183], v[76:79], v[244:247], v[180:183]
    ds_read_b128 v[240:243], v4 offset:20480
    s_add_u32 s52, s57, s58
    v_mfma_f32_16x16x32_bf16 v[172:175], v[72:75], v[244:247], v[172:175]
    s_mul_i32 s52, s52, 32768
    s_lshl_b32 s66, s58, 1
    s_waitcnt lgkmcnt(3)
    v_mfma_f32_16x16x32_bf16 v[168:171], v[80:83], v[248:251], v[168:171]
    ds_read_b128 v[244:247], v4 offset:22528
    s_sub_u32 s53, s57, s66
    v_mfma_f32_16x16x32_bf16 v[176:179], v[84:87], v[248:251], v[176:179]
    s_add_u32 s53, s53, 2
    s_mul_i32 s53, s53, 32768
    v_mfma_f32_16x16x32_bf16 v[180:183], v[84:87], v[252:255], v[180:183]
    ds_read_b128 v[248:251], v3 offset:24576
    s_lshl_b32 s58, s58, 3
    v_mfma_f32_16x16x32_bf16 v[172:175], v[80:83], v[252:255], v[172:175]
    s_add_u32 s54, s53, s58
    s_lshl_b32 s66, s4, 1
    s_waitcnt lgkmcnt(3)
    v_mfma_f32_16x16x32_bf16 v[168:171], v[88:91], v[232:235], v[168:171]
    ds_read_b128 v[252:255], v3 offset:26624
    s_add_u32 s66, s66, s3
    v_mfma_f32_16x16x32_bf16 v[176:179], v[92:95], v[232:235], v[176:179]
    s_sub_i32 s66, s66, 2
    s_lshl_b32 s67, s4, 2
    v_mfma_f32_16x16x32_bf16 v[180:183], v[92:95], v[236:239], v[180:183]
    ds_read_b128 v[232:235], v4 offset:24576
    s_add_u32 s67, s67, s3
    v_mfma_f32_16x16x32_bf16 v[172:175], v[88:91], v[236:239], v[172:175]
    s_lshl_b32 s55, s67, 10
    s_lshl_b32 s67, s67, 1
    s_waitcnt lgkmcnt(3)
    v_mfma_f32_16x16x32_bf16 v[168:171], v[96:99], v[240:243], v[168:171]
    ds_read_b128 v[236:239], v4 offset:26624
    s_lshl_b32 s68, s66, 2
    v_mfma_f32_16x16x32_bf16 v[176:179], v[100:103], v[240:243], v[176:179]
    s_lshl_b32 s70, s66, 11
    s_cmp_ge_i32 s66, 0
    v_mfma_f32_16x16x32_bf16 v[180:183], v[100:103], v[244:247], v[180:183]
    ds_read_b128 v[240:243], v3 offset:28672
    s_cselect_b32 s59, 1, 0
    v_mfma_f32_16x16x32_bf16 v[172:175], v[96:99], v[244:247], v[172:175]
    s_cselect_b32 s70, s70, 1073741824
    s_cselect_b32 s56, 0x3f803f80, 0
    s_waitcnt lgkmcnt(3)
    v_mfma_f32_16x16x32_bf16 v[168:171], v[104:107], v[248:251], v[168:171]
    ds_read_b128 v[244:247], v3 offset:30720
    v_lshlrev_b32 v206, 4, v0
    v_mfma_f32_16x16x32_bf16 v[176:179], v[108:111], v[248:251], v[176:179]
    v_add_u32 v202, s70, v206
    v_lshrrev_b32 v210, 2, v0
    v_mfma_f32_16x16x32_bf16 v[180:183], v[108:111], v[252:255], v[180:183]
    ds_read_b128 v[248:251], v4 offset:28672
    v_mul_u32_u24 v210, s59, v210
    v_mfma_f32_16x16x32_bf16 v[172:175], v[104:107], v[252:255], v[172:175]
    v_and_b32 v211, 1, v0
    v_lshl_add_u32 v211, v211, 1, s57
    s_waitcnt lgkmcnt(3)
    v_mfma_f32_16x16x32_bf16 v[168:171], v[112:115], v[232:235], v[168:171]
    ds_read_b128 v[252:255], v4 offset:30720
    v_lshrrev_b32 v211, 2, v211
    v_mfma_f32_16x16x32_bf16 v[176:179], v[116:119], v[232:235], v[176:179]
    v_mad_u32_u24 v211, v210, 20, v211
    v_bfe_u32 v213, v0, 1, 1
    v_mfma_f32_16x16x32_bf16 v[180:183], v[116:119], v[236:239], v[180:183]
    ds_read_b128 v[232:235], v3 offset:32768
    v_mad_u32_u24 v212, v213, 3, s68
    v_mfma_f32_16x16x32_bf16 v[172:175], v[112:115], v[236:239], v[172:175]
    v_add_u32 v213, s67, v213
    v_cmp_eq_u32 vcc, 0, v210
    s_waitcnt lgkmcnt(3)
    v_mfma_f32_16x16x32_bf16 v[168:171], v[120:123], v[240:243], v[168:171]
    ds_read_b128 v[236:239], v3 offset:34816
    v_and_b32 v214, 31, v0
    v_mfma_f32_16x16x32_bf16 v[176:179], v[124:127], v[240:243], v[176:179]
    v_lshrrev_b32 v215, 5, v0
    v_cndmask_b32 v212, v212, v213, vcc
    v_mfma_f32_16x16x32_bf16 v[180:183], v[124:127], v[244:247], v[180:183]
    ds_read_b128 v[240:243], v4 offset:32768
    v_mul_u32_u24 v212, 52, v212
    v_mfma_f32_16x16x32_bf16 v[172:175], v[120:123], v[244:247], v[172:175]
    v_lshrrev_b32 v212, 8, v212
    v_mad_u32_u24 v211, v212, 60, v211
    s_waitcnt lgkmcnt(3)
    v_mfma_f32_16x16x32_bf16 v[168:171], v[128:131], v[248:251], v[168:171]
    ds_read_b128 v[244:247], v4 offset:34816
    v_lshlrev_b32 v211, 7, v211
    v_mfma_f32_16x16x32_bf16 v[176:179], v[132:135], v[248:251], v[176:179]
    v_add_u32 v200, 14680064, v211
    s_max_i32 s68, s68, 0
    v_mfma_f32_16x16x32_bf16 v[180:183], v[132:135], v[252:255], v[180:183]
    ds_read_b128 v[248:251], v3 offset:36864
    v_add_u32 v210, s68, v215
    v_mfma_f32_16x16x32_bf16 v[172:175], v[128:131], v[252:255], v[172:175]
    v_mul_u32_u24 v211, 52, v210
    v_lshrrev_b32 v211, 8, v211
    s_waitcnt lgkmcnt(3)
    v_mfma_f32_16x16x32_bf16 v[168:171], v[136:139], v[232:235], v[168:171]
    ds_read_b128 v[252:255], v3 offset:38912
    v_mul_u32_u24 v211, 5, v211
    v_mfma_f32_16x16x32_bf16 v[176:179], v[140:143], v[232:235], v[176:179]
    v_sub_u32 v210, v210, v211
    v_cmp_gt_u32 s[60:61], 3, v210
    v_mfma_f32_16x16x32_bf16 v[180:183], v[140:143], v[236:239], v[180:183]
    ds_read_b128 v[232:235], v4 offset:36864
    v_add_u32 v210, s68, v215
    v_mfma_f32_16x16x32_bf16 v[172:175], v[136:139], v[236:239], v[172:175]
    v_add_u32 v210, 2, v210
    v_mul_u32_u24 v211, 52, v210
    s_waitcnt lgkmcnt(3)
    v_mfma_f32_16x16x32_bf16 v[168:171], v[144:147], v[240:243], v[168:171]
    ds_read_b128 v[236:239], v4 offset:38912
    v_lshrrev_b32 v211, 8, v211
    v_mfma_f32_16x16x32_bf16 v[176:179], v[148:151], v[240:243], v[176:179]
    v_mul_u32_u24 v211, 5, v211
    v_sub_u32 v210, v210, v211
    v_mfma_f32_16x16x32_bf16 v[180:183], v[148:151], v[244:247], v[180:183]
    v_cmp_gt_u32 s[62:63], 3, v210
    v_mfma_f32_16x16x32_bf16 v[172:175], v[144:147], v[244:247], v[172:175]
    s_lshl_b32 s70, s4, 9
    s_add_u32 s70, s70, 14927360
    s_waitcnt lgkmcnt(2)
    v_mfma_f32_16x16x32_bf16 v[168:171], v[152:155], v[248:251], v[168:171]
    v_lshl_add_u32 v201, v214, 4, s70
    v_mfma_f32_16x16x32_bf16 v[176:179], v[156:159], v[248:251], v[176:179]
    v_lshl_add_u32 v210, v214, 4, s55
    v_mul_u32_u24 v211, 32768, v215
    v_mfma_f32_16x16x32_bf16 v[180:183], v[156:159], v[252:255], v[180:183]
    v_add3_u32 v203, v210, v211, s52
    v_mfma_f32_16x16x32_bf16 v[172:175], v[152:155], v[252:255], v[172:175]
    v_lshl_add_u32 v204, v215, 30, v210
    s_lshl_b32 s66, s3, 11
    s_waitcnt lgkmcnt(0)
    v_mfma_f32_16x16x32_bf16 v[168:171], v[160:163], v[232:235], v[168:171]
    s_sub_u32 s66, s66, s58
    v_mfma_f32_16x16x32_bf16 v[176:179], v[164:167], v[232:235], v[176:179]
    s_add_u32 s66, s66, 41288
    v_add_u32 v205, s66, v206
    v_mfma_f32_16x16x32_bf16 v[180:183], v[164:167], v[236:239], v[180:183]
    s_lshl_b32 s70, s3, 10
    v_mfma_f32_16x16x32_bf16 v[172:175], v[160:163], v[236:239], v[172:175]
    v_lshl_add_u32 v210, v214, 4, s70
    v_mul_u32_u24 v211, 8256, v215
    v_add_u32 v207, v210, v211
    s_add_u32 s66, s58, 16512
    v_add_u32 v208, s66, v210
    v_bfe_u32 v210, v0, 2, 2
    v_lshl_add_u32 v210, v215, 2, v210
    v_bfe_u32 v211, v0, 1, 1
    v_mul_u32_u24 v211, 8256, v211
    v_and_b32 v212, 1, v0
    v_lshl_add_u32 v211, v212, 3, v211
    v_and_b32 v212, 3, v0
    v_pk_mul_f32 v[168:169], v[168:169], s[10:11] op_sel_hi:[1,0]
    v_pk_mul_f32 v[170:171], v[170:171], s[10:11] op_sel_hi:[1,0]
    v_pk_mul_f32 v[172:173], v[172:173], s[10:11] op_sel_hi:[1,0]
    v_pk_mul_f32 v[174:175], v[174:175], s[10:11] op_sel_hi:[1,0]
    v_pk_mul_f32 v[176:177], v[176:177], s[10:11] op_sel_hi:[1,0]
    v_pk_mul_f32 v[178:179], v[178:179], s[10:11] op_sel_hi:[1,0]
    v_pk_mul_f32 v[180:181], v[180:181], s[10:11] op_sel_hi:[1,0]
    v_pk_mul_f32 v[182:183], v[182:183], s[10:11] op_sel_hi:[1,0]
    v_cvt_pk_bf16_f32 v168, v168, v169
    v_cvt_pk_bf16_f32 v169, v170, v171
    v_cvt_pk_bf16_f32 v170, v172, v173
    v_cvt_pk_bf16_f32 v171, v174, v175
    v_cvt_pk_bf16_f32 v172, v176, v177
    v_cvt_pk_bf16_f32 v173, v178, v179
    v_cvt_pk_bf16_f32 v174, v180, v181
    v_cvt_pk_bf16_f32 v175, v182, v183
    v_permlane16_swap_b32 v168, v170
    v_permlane16_swap_b32 v169, v171
    v_permlane16_swap_b32 v172, v174
    v_permlane16_swap_b32 v173, v175
    buffer_store_dwordx4 v[168:171], v6, s[48:51], 0 offen offset:2048 sc1
    buffer_store_dwordx4 v[172:175], v6, s[48:51], s11 offen offset:2048 sc1
    v_min_u32 v212, 1, v212
    v_lshlrev_b32 v212, 3, v212
    v_xor_b32 v212, s58, v212
    v_and_b32 v213, 16, v0
    v_cmp_eq_u32 vcc, 0, v213
    v_add_u32 v212, 16512, v212
    s_add_u32 s70, s70, 24768
    v_cndmask_b32 v211, v212, v211, vcc
    v_lshl_add_u32 v210, v210, 4, v211
    v_add_u32 v209, s70, v210
.La_flag:
    s_mov_b32 s70, 99840
    s_mov_b64 exec, 0xff0
    buffer_load_dwordx2 v[246:247], v200, s[48:51], s70 offen sc1
    s_mov_b64 exec, -1
    s_waitcnt vmcnt(1)
    v_mov_b32 v248, s64
    v_mov_b32 v249, s65
    v_mov_b32 v250, 0
    v_mov_b32 v251, 0
    v_lshlrev_b32 v252, 4, v0
    s_mov_b64 exec, 0xff
    buffer_store_dwordx4 v[248:251], v252, s[48:51], s12 offen sc1
    s_mov_b64 exec, -1
    s_waitcnt vmcnt(1)
    v_cmp_ne_u64 vcc, s[64:65], v[246:247]
    s_nop 0
    s_and_b32 s66, vcc_lo, 0xff0
    s_cbranch_scc0 .La_early
    s_branch .La_att
.La_light:
    s_waitcnt lgkmcnt(0)
    s_waitcnt lgkmcnt(0)
    s_cmp_lg_u32 s65, 0
    s_cbranch_scc1 .Ltagd_29
    v_mov_b32 v194, 0
    s_mov_b32 s74, 16384
.Ltag_28:
    global_load_dwordx2 v[192:193], v194, s[36:37] sc1
    s_waitcnt vmcnt(0)
    v_readfirstlane_b32 s64, v192
    v_readfirstlane_b32 s65, v193
    s_nop 0
    s_cmp_lg_u32 s65, 0
    s_cbranch_scc1 .Ltagd_29
    s_sub_u32 s74, s74, 1
    s_cbranch_scc0 .Ltag_28
.Ltagd_29:
    v_mfma_f32_16x16x32_bf16 v[228:231], v[148:151], v[252:255], v[228:231]
    v_mfma_f32_16x16x32_bf16 v[220:223], v[144:147], v[252:255], v[220:223]
    v_mfma_f32_16x16x32_bf16 v[216:219], v[152:155], v[232:235], v[216:219]
    v_mfma_f32_16x16x32_bf16 v[224:227], v[156:159], v[232:235], v[224:227]
    v_mfma_f32_16x16x32_bf16 v[228:231], v[156:159], v[236:239], v[228:231]
    v_mfma_f32_16x16x32_bf16 v[220:223], v[152:155], v[236:239], v[220:223]
    v_mfma_f32_16x16x32_bf16 v[216:219], v[160:163], v[240:243], v[216:219]
    v_mfma_f32_16x16x32_bf16 v[224:227], v[164:167], v[240:243], v[224:227]
    v_mfma_f32_16x16x32_bf16 v[228:231], v[164:167], v[244:247], v[228:231]
    v_mfma_f32_16x16x32_bf16 v[220:223], v[160:163], v[244:247], v[220:223]
    s_nop 4
    v_pk_mul_f32 v[216:217], v[216:217], s[10:11] op_sel_hi:[1,0]
    v_pk_mul_f32 v[218:219], v[218:219], s[10:11] op_sel_hi:[1,0]
    s_nop 0
    v_pk_mul_f32 v[220:221], v[220:221], s[10:11] op_sel_hi:[1,0]
    v_pk_mul_f32 v[222:223], v[222:223], s[10:11] op_sel_hi:[1,0]
    v_pk_mul_f32 v[224:225], v[224:225], s[10:11] op_sel_hi:[1,0]
    v_pk_mul_f32 v[226:227], v[226:227], s[10:11] op_sel_hi:[1,0]
    v_pk_mul_f32 v[228:229], v[228:229], s[10:11] op_sel_hi:[1,0]
    v_pk_mul_f32 v[230:231], v[230:231], s[10:11] op_sel_hi:[1,0]
    v_cvt_pk_bf16_f32 v216, v216, v217
    v_cvt_pk_bf16_f32 v217, v218, v219
    v_cvt_pk_bf16_f32 v218, v220, v221
    v_cvt_pk_bf16_f32 v219, v222, v223
    v_cvt_pk_bf16_f32 v220, v224, v225
    v_cvt_pk_bf16_f32 v221, v226, v227
    v_cvt_pk_bf16_f32 v222, v228, v229
    v_cvt_pk_bf16_f32 v223, v230, v231
    v_permlane16_swap_b32 v216, v218
    v_permlane16_swap_b32 v217, v219
    v_permlane16_swap_b32 v220, v222
    v_permlane16_swap_b32 v221, v223
    buffer_store_dwordx4 v[216:219], v6, s[48:51], 0 offen offset:1536 sc1
    buffer_store_dwordx4 v[220:223], v6, s[48:51], s11 offen offset:1536 sc1
    s_mul_i32 s57, s5, 5
    s_lshr_b32 s57, s57, 1
    s_and_b32 s58, s5, 1
    s_add_u32 s52, s57, s58
    s_mul_i32 s52, s52, 32768
    s_lshl_b32 s66, s58, 1
    s_sub_u32 s53, s57, s66
    s_add_u32 s53, s53, 2
    s_mul_i32 s53, s53, 32768
    s_lshl_b32 s58, s58, 3
    s_add_u32 s54, s53, s58
    s_lshl_b32 s66, s4, 1
    s_add_u32 s66, s66, s3
    s_sub_i32 s66, s66, 2
    s_lshl_b32 s67, s4, 2
    s_add_u32 s67, s67, s3
    s_lshl_b32 s55, s67, 10
    s_lshl_b32 s67, s67, 1
    s_lshl_b32 s68, s66, 2
    s_lshl_b32 s70, s66, 11
    s_cmp_ge_i32 s66, 0
    s_cselect_b32 s59, 1, 0
    s_cselect_b32 s70, s70, 1073741824
    s_cselect_b32 s56, 0x3f803f80, 0
    v_lshlrev_b32 v206, 4, v0
    v_add_u32 v202, s70, v206
    v_lshrrev_b32 v210, 2, v0
    v_mul_u32_u24 v210, s59, v210
    v_and_b32 v211, 1, v0
    v_lshl_add_u32 v211, v211, 1, s57
    v_lshrrev_b32 v211, 2, v211
    v_mad_u32_u24 v211, v210, 20, v211
    v_bfe_u32 v213, v0, 1, 1
    v_mad_u32_u24 v212, v213, 3, s68
    v_add_u32 v213, s67, v213
    v_cmp_eq_u32 vcc, 0, v210
    v_and_b32 v214, 31, v0
    v_lshrrev_b32 v215, 5, v0
    v_cndmask_b32 v212, v212, v213, vcc
    v_mul_u32_u24 v212, 52, v212
    v_lshrrev_b32 v212, 8, v212
    v_mad_u32_u24 v211, v212, 60, v211
    v_lshlrev_b32 v211, 7, v211
    v_add_u32 v200, 14680064, v211
    s_max_i32 s68, s68, 0
    v_add_u32 v210, s68, v215
    v_mul_u32_u24 v211, 52, v210
    v_lshrrev_b32 v211, 8, v211
    v_mul_u32_u24 v211, 5, v211
    v_sub_u32 v210, v210, v211
    v_cmp_gt_u32 s[60:61], 3, v210
    v_add_u32 v210, s68, v215
    v_add_u32 v210, 2, v210
    v_mul_u32_u24 v211, 52, v210
    v_lshrrev_b32 v211, 8, v211
    v_mul_u32_u24 v211, 5, v211
    v_sub_u32 v210, v210, v211
    v_cmp_gt_u32 s[62:63], 3, v210
    s_lshl_b32 s70, s4, 9
    s_add_u32 s70, s70, 14927360
    v_lshl_add_u32 v201, v214, 4, s70
    v_lshl_add_u32 v210, v214, 4, s55
    v_mul_u32_u24 v211, 32768, v215
    v_add3_u32 v203, v210, v211, s52
    v_lshl_add_u32 v204, v215, 30, v210
    s_lshl_b32 s66, s3, 11
    s_sub_u32 s66, s66, s58
    s_add_u32 s66, s66, 41288
    v_add_u32 v205, s66, v206
    s_lshl_b32 s70, s3, 10
    v_lshl_add_u32 v210, v214, 4, s70
    v_mul_u32_u24 v211, 8256, v215
    v_add_u32 v207, v210, v211
    s_add_u32 s66, s58, 16512
    v_add_u32 v208, s66, v210
    v_bfe_u32 v210, v0, 2, 2
    v_lshl_add_u32 v210, v215, 2, v210
    v_bfe_u32 v211, v0, 1, 1
    v_mul_u32_u24 v211, 8256, v211
    v_and_b32 v212, 1, v0
    v_lshl_add_u32 v211, v212, 3, v211
    v_and_b32 v212, 3, v0
    v_min_u32 v212, 1, v212
    v_lshlrev_b32 v212, 3, v212
    v_xor_b32 v212, s58, v212
    v_and_b32 v213, 16, v0
    v_cmp_eq_u32 vcc, 0, v213
    v_add_u32 v212, 16512, v212
    s_add_u32 s70, s70, 24768
    v_cndmask_b32 v211, v212, v211, vcc
    v_lshl_add_u32 v210, v210, 4, v211
    v_add_u32 v209, s70, v210
    s_waitcnt vmcnt(2)
    v_mov_b32 v192, s64
    v_mov_b32 v193, s65
    v_mov_b32 v194, 0
    v_mov_b32 v195, 0
    v_lshlrev_b32 v196, 4, v0
    s_mov_b64 exec, 0xff
    buffer_store_dwordx4 v[192:195], v196, s[48:51], s13 offen sc1
    s_mov_b64 exec, -1
    s_branch .La_flag
.La_att:
    s_setprio 2
    s_mov_b32 s70, 99840
    s_mov_b32 s74, 16384
    s_mov_b64 exec, 0xff0
.Lpoll_30:
    buffer_load_dwordx2 v[248:249], v200, s[48:51], s70 offen sc1
    s_waitcnt vmcnt(0)
    v_cmp_ne_u64 vcc, s[64:65], v[248:249]
    s_nop 0
    s_and_b64 exec, exec, vcc
    s_cbranch_scc0 .Lpolld_31
    s_sleep 1
    s_sub_u32 s74, s74, 1
    s_cbranch_scc0 .Lpoll_30
.Lpolld_31:
    s_mov_b64 exec, -1
.La_early:
    s_lshl_b32 s71, s3, 11
    s_and_b64 exec, s[60:61], -1
    s_cbranch_scc0 .Lkv_32
    s_add_u32 m0, s71, 41280
    s_add_u32 s70, s53, 5242880
    buffer_load_dwordx4 v202, s[48:51], s70 offen offset:0 sc1 lds
    s_add_u32 m0, s71, 0
    s_add_u32 s70, s52, 2621440
    buffer_load_dwordx4 v202, s[48:51], s70 offen offset:0 sc1 lds
    s_add_u32 m0, s71, 8256
    s_add_u32 s70, s52, 2654208
    buffer_load_dwordx4 v202, s[48:51], s70 offen offset:0 sc1 lds
    s_add_u32 m0, s71, 16512
    s_add_u32 s70, s53, 2621440
    buffer_load_dwordx4 v202, s[48:51], s70 offen offset:0 sc1 lds
    s_add_u32 m0, s71, 24768
    s_add_u32 s70, s52, 5242880
    buffer_load_dwordx4 v202, s[48:51], s70 offen offset:0 sc1 lds
    s_add_u32 m0, s71, 33024
    s_add_u32 s70, s52, 5275648
    buffer_load_dwordx4 v202, s[48:51], s70 offen offset:0 sc1 lds
.Lkv_32:
    s_and_b64 exec, s[62:63], -1
    s_cbranch_scc0 .Lkv_33
    s_add_u32 m0, s71, 41280
    s_add_u32 s70, s53, 5242880
    buffer_load_dwordx4 v202, s[48:51], s70 offen offset:1024 sc1 lds
    s_add_u32 m0, s71, 0
    s_add_u32 s70, s52, 2621440
    buffer_load_dwordx4 v202, s[48:51], s70 offen offset:1024 sc1 lds
    s_add_u32 m0, s71, 8256
    s_add_u32 s70, s52, 2654208
    buffer_load_dwordx4 v202, s[48:51], s70 offen offset:1024 sc1 lds
    s_add_u32 m0, s71, 16512
    s_add_u32 s70, s53, 2621440
    buffer_load_dwordx4 v202, s[48:51], s70 offen offset:1024 sc1 lds
    s_add_u32 m0, s71, 24768
    s_add_u32 s70, s52, 5242880
    buffer_load_dwordx4 v202, s[48:51], s70 offen offset:1024 sc1 lds
    s_add_u32 m0, s71, 33024
    s_add_u32 s70, s52, 5275648
    buffer_load_dwordx4 v202, s[48:51], s70 offen offset:1024 sc1 lds
.Lkv_33:
    s_mov_b64 exec, -1
    buffer_load_dwordx4 v[172:175], v201, s[48:51], 0 offen sc1
    s_mov_b32 s74, 16384
    s_mov_b64 exec, 0xfff
.Lpoll_34:
    buffer_load_dwordx2 v[248:249], v200, s[48:51], 0 offen sc1
    s_waitcnt vmcnt(0)
    v_cmp_ne_u64 vcc, s[64:65], v[248:249]
    s_nop 0
    s_and_b64 exec, exec, vcc
    s_cbranch_scc0 .Lpolld_35
    s_sleep 1
    s_sub_u32 s74, s74, 1
    s_cbranch_scc0 .Lpoll_34
.Lpolld_35:
    s_mov_b64 exec, -1
    buffer_load_dwordx4 v[128:131], v203, s[48:51], 0 offen offset:0 sc1
    buffer_load_dwordx2 v[132:133], v204, s[48:51], s54 offen offset:0 sc1
    buffer_load_dwordx4 v[134:137], v203, s[48:51], 0 offen offset:512 sc1
    buffer_load_dwordx2 v[138:139], v204, s[48:51], s54 offen offset:512 sc1
    s_lshl_b32 s71, s3, 11
    s_not_b64 exec, s[60:61]
    s_cbranch_scc0 .Lkv_36
    s_add_u32 m0, s71, 41280
    s_add_u32 s70, s53, 5242880
    buffer_load_dwordx4 v202, s[48:51], s70 offen offset:0 sc1 lds
    s_add_u32 m0, s71, 0
    s_add_u32 s70, s52, 2621440
    buffer_load_dwordx4 v202, s[48:51], s70 offen offset:0 sc1 lds
    s_add_u32 m0, s71, 8256
    s_add_u32 s70, s52, 2654208
    buffer_load_dwordx4 v202, s[48:51], s70 offen offset:0 sc1 lds
    s_add_u32 m0, s71, 16512
    s_add_u32 s70, s53, 2621440
    buffer_load_dwordx4 v202, s[48:51], s70 offen offset:0 sc1 lds
    s_add_u32 m0, s71, 24768
    s_add_u32 s70, s52, 5242880
    buffer_load_dwordx4 v202, s[48:51], s70 offen offset:0 sc1 lds
    s_add_u32 m0, s71, 33024
    s_add_u32 s70, s52, 5275648
    buffer_load_dwordx4 v202, s[48:51], s70 offen offset:0 sc1 lds
.Lkv_36:
    s_not_b64 exec, s[62:63]
    s_cbranch_scc0 .Lkv_37
    s_add_u32 m0, s71, 41280
    s_add_u32 s70, s53, 5242880
    buffer_load_dwordx4 v202, s[48:51], s70 offen offset:1024 sc1 lds
    s_add_u32 m0, s71, 0
    s_add_u32 s70, s52, 2621440
    buffer_load_dwordx4 v202, s[48:51], s70 offen offset:1024 sc1 lds
    s_add_u32 m0, s71, 8256
    s_add_u32 s70, s52, 2654208
    buffer_load_dwordx4 v202, s[48:51], s70 offen offset:1024 sc1 lds
    s_add_u32 m0, s71, 16512
    s_add_u32 s70, s53, 2621440
    buffer_load_dwordx4 v202, s[48:51], s70 offen offset:1024 sc1 lds
    s_add_u32 m0, s71, 24768
    s_add_u32 s70, s52, 5242880
    buffer_load_dwordx4 v202, s[48:51], s70 offen offset:1024 sc1 lds
    s_add_u32 m0, s71, 33024
    s_add_u32 s70, s52, 5275648
    buffer_load_dwordx4 v202, s[48:51], s70 offen offset:1024 sc1 lds
.Lkv_37:
    s_mov_b64 exec, -1
    v_and_b32 v7, 31, v0
    v_lshrrev_b32 v8, 5, v0
    v_lshlrev_b32 v9, 2, v8
    v_sub_u32 v9, v7, v9
    v_mov_b32 v10, 0xf149f2ca
    v_cmp_le_i32 vcc, 0, v9
    v_cmp_le_i32 s[66:67], 1, v9
    s_nop 0
    v_cndmask_b32 v112, 0, v10, vcc
    v_cndmask_b32 v113, 0, v10, s[66:67]
    v_sub_f32 v96, v10, v112
    v_cmp_le_i32 vcc, 2, v9
    v_cmp_le_i32 s[66:67], 3, v9
    v_sub_f32 v97, v10, v113
    v_cndmask_b32 v114, 0, v10, vcc
    v_cndmask_b32 v115, 0, v10, s[66:67]
    v_sub_f32 v98, v10, v114
    v_cmp_le_i32 vcc, 8, v9
    v_cmp_le_i32 s[66:67], 9, v9
    v_sub_f32 v99, v10, v115
    v_cndmask_b32 v116, 0, v10, vcc
    v_cndmask_b32 v117, 0, v10, s[66:67]
    v_sub_f32 v100, v10, v116
    v_cmp_le_i32 vcc, 10, v9
    v_cmp_le_i32 s[66:67], 11, v9
    v_sub_f32 v101, v10, v117
    v_cndmask_b32 v118, 0, v10, vcc
    v_cndmask_b32 v119, 0, v10, s[66:67]
    v_sub_f32 v102, v10, v118
    v_cmp_le_i32 vcc, 16, v9
    v_cmp_le_i32 s[66:67], 17, v9
    v_sub_f32 v103, v10, v119
    v_cndmask_b32 v120, 0, v10, vcc
    v_cndmask_b32 v121, 0, v10, s[66:67]
    v_sub_f32 v104, v10, v120
    v_cmp_le_i32 vcc, 18, v9
    v_cmp_le_i32 s[66:67], 19, v9
    v_sub_f32 v105, v10, v121
    v_cndmask_b32 v122, 0, v10, vcc
    v_cndmask_b32 v123, 0, v10, s[66:67]
    v_sub_f32 v106, v10, v122
    v_cmp_le_i32 vcc, 24, v9
    v_cmp_le_i32 s[66:67], 25, v9
    v_sub_f32 v107, v10, v123
    v_cndmask_b32 v124, 0, v10, vcc
    v_cndmask_b32 v125, 0, v10, s[66:67]
    v_sub_f32 v108, v10, v124
    v_cmp_le_i32 vcc, 26, v9
    v_cmp_le_i32 s[66:67], 27, v9
    v_sub_f32 v109, v10, v125
    v_cndmask_b32 v126, 0, v10, vcc
    v_cndmask_b32 v127, 0, v10, s[66:67]
    v_sub_f32 v110, v10, v126
    v_sub_f32 v111, v10, v127
    v_cmp_ne_u64 vcc, s[64:65], v[172:173]
    s_nop 0
    s_cbranch_vccnz .La_idp
.La_ids:
    s_getreg_b32 s67, hwreg(HW_REG_XCC_ID)
    v_cmp_ne_u32 vcc, s67, v174
    s_nop 0
    s_cmp_eq_u64 vcc, 0
    s_cselect_b32 s75, 1, 0
    v_mov_b32 v250, s56
    v_mov_b32 v251, s56
    s_waitcnt vmcnt(0)
    ds_write_b64 v205, v[250:251]
    ds_write_b64 v205, v[250:251] offset:1024
    v_mov_b32 v250, 163584
    v_mov_b32 v251, 1
    s_mov_b64 exec, 1
    ds_add_u32 v250, v251
    s_mov_b64 exec, -1
    v_mov_b32 v250, 163584
    s_mov_b32 s74, 65536
.Llw_38:
    ds_read_b32 v251, v250
    s_waitcnt lgkmcnt(0)
    v_readfirstlane_b32 s72, v251
    s_nop 0
    s_cmp_ge_u32 s72, 4
    s_cbranch_scc1 .Llwd_39
    s_sub_u32 s74, s74, 1
    s_cbranch_scc0 .Llw_38
.Llwd_39:
    ds_read_b128 v[140:143], v207 offset:0
    ds_read_b64 v[144:145], v208 offset:0
    ds_read_b128 v[146:149], v207 offset:512
    ds_read_b64 v[150:151], v208 offset:512
    ds_read_b64_tr_b16 v[152:153], v209 offset:0
    ds_read_b64_tr_b16 v[154:155], v209 offset:128
    ds_read_b64_tr_b16 v[156:157], v209 offset:256
    ds_read_b64_tr_b16 v[158:159], v209 offset:384
    s_waitcnt lgkmcnt(6)
    v_mfma_f32_32x32x16_bf16 v[16:31], v[140:143], v[128:131], v[112:127]
    v_mfma_f32_32x32x8_bf16 v[16:31], v[144:145], v[132:133], v[16:31]
    s_nop 11
    v_exp_f32 v16, v16
    v_exp_f32 v17, v17
    v_exp_f32 v18, v18
    v_exp_f32 v19, v19
    v_cvt_pk_bf16_f32 v48, v16, v17
    v_cvt_pk_bf16_f32 v49, v18, v19
    s_waitcnt lgkmcnt(4)
    v_mfma_f32_32x32x16_bf16 v[32:47], v[146:149], v[128:131], 0
    ds_read_b128 v[140:143], v207 offset:1024
    ds_read_b64 v[144:145], v208 offset:1024
    v_exp_f32 v20, v20
    v_exp_f32 v21, v21
    v_exp_f32 v22, v22
    v_exp_f32 v23, v23
    v_cvt_pk_bf16_f32 v50, v20, v21
    v_cvt_pk_bf16_f32 v51, v22, v23
    v_mfma_f32_32x32x8_bf16 v[32:47], v[150:151], v[132:133], v[32:47]
    ds_read_b64_tr_b16 v[160:161], v209 offset:512
    ds_read_b64_tr_b16 v[162:163], v209 offset:640
    v_exp_f32 v24, v24
    v_exp_f32 v25, v25
    v_exp_f32 v26, v26
    v_exp_f32 v27, v27
    v_cvt_pk_bf16_f32 v52, v24, v25
    v_cvt_pk_bf16_f32 v53, v26, v27
    ds_read_b64_tr_b16 v[164:165], v209 offset:768
    ds_read_b64_tr_b16 v[166:167], v209 offset:896
    v_exp_f32 v28, v28
    v_exp_f32 v29, v29
    v_exp_f32 v30, v30
    v_exp_f32 v31, v31
    v_cvt_pk_bf16_f32 v54, v28, v29
    v_cvt_pk_bf16_f32 v55, v30, v31
    s_waitcnt lgkmcnt(6)
    v_mfma_f32_32x32x16_bf16 v[64:79], v[152:155], v[48:51], 0
    v_exp_f32 v32, v32
    v_exp_f32 v33, v33
    v_exp_f32 v34, v34
    v_exp_f32 v35, v35
    v_cvt_pk_bf16_f32 v56, v32, v33
    v_cvt_pk_bf16_f32 v57, v34, v35
    v_mfma_f32_32x32x16_bf16 v[16:31], v[146:149], v[134:137], v[112:127]
    ds_read_b64_tr_b16 v[152:153], v209 offset:1024
    v_exp_f32 v36, v36
    v_exp_f32 v37, v37
    v_exp_f32 v38, v38
    v_exp_f32 v39, v39
    v_cvt_pk_bf16_f32 v58, v36, v37
    v_cvt_pk_bf16_f32 v59, v38, v39
    v_mfma_f32_32x32x8_bf16 v[16:31], v[150:151], v[138:139], v[16:31]
    ds_read_b64_tr_b16 v[154:155], v209 offset:1152
    v_exp_f32 v40, v40
    v_exp_f32 v41, v41
    v_exp_f32 v42, v42
    v_exp_f32 v43, v43
    v_cvt_pk_bf16_f32 v60, v40, v41
    v_cvt_pk_bf16_f32 v61, v42, v43
    v_mfma_f32_32x32x16_bf16 v[64:79], v[156:159], v[52:55], v[64:79]
    ds_read_b64_tr_b16 v[156:157], v209 offset:1280
    v_exp_f32 v44, v44
    v_exp_f32 v45, v45
    v_exp_f32 v46, v46
    v_exp_f32 v47, v47
    v_cvt_pk_bf16_f32 v62, v44, v45
    v_cvt_pk_bf16_f32 v63, v46, v47
    s_waitcnt lgkmcnt(3)
    v_mfma_f32_32x32x16_bf16 v[64:79], v[160:163], v[56:59], v[64:79]
    ds_read_b64_tr_b16 v[158:159], v209 offset:1408
    v_exp_f32 v16, v16
    v_exp_f32 v17, v17
    v_exp_f32 v18, v18
    v_exp_f32 v19, v19
    v_cvt_pk_bf16_f32 v48, v16, v17
    v_cvt_pk_bf16_f32 v49, v18, v19
    v_mfma_f32_32x32x16_bf16 v[32:47], v[140:143], v[128:131], 0
    ds_read_b128 v[146:149], v207 offset:1536
    v_exp_f32 v20, v20
    v_exp_f32 v21, v21
    v_exp_f32 v22, v22
    v_exp_f32 v23, v23
    v_cvt_pk_bf16_f32 v50, v20, v21
    v_cvt_pk_bf16_f32 v51, v22, v23
    v_mfma_f32_32x32x8_bf16 v[32:47], v[144:145], v[132:133], v[32:47]
    ds_read_b64 v[150:151], v208 offset:1536
    v_exp_f32 v24, v24
    v_exp_f32 v25, v25
    v_exp_f32 v26, v26
    v_exp_f32 v27, v27
    v_cvt_pk_bf16_f32 v52, v24, v25
    v_cvt_pk_bf16_f32 v53, v26, v27
    v_mfma_f32_32x32x16_bf16 v[64:79], v[164:167], v[60:63], v[64:79]
    v_exp_f32 v28, v28
    v_exp_f32 v29, v29
    v_exp_f32 v30, v30
    v_exp_f32 v31, v31
    v_cvt_pk_bf16_f32 v54, v28, v29
    v_cvt_pk_bf16_f32 v55, v30, v31
    v_mfma_f32_32x32x16_bf16 v[80:95], v[160:163], v[48:51], 0
    v_exp_f32 v32, v32
    v_exp_f32 v33, v33
    v_exp_f32 v34, v34
    v_exp_f32 v35, v35
    v_cvt_pk_bf16_f32 v56, v32, v33
    v_cvt_pk_bf16_f32 v57, v34, v35
    v_mfma_f32_32x32x16_bf16 v[16:31], v[140:143], v[134:137], 0
    ds_read_b64_tr_b16 v[160:161], v209 offset:1536
    v_exp_f32 v36, v36
    v_exp_f32 v37, v37
    v_exp_f32 v38, v38
    v_exp_f32 v39, v39
    v_cvt_pk_bf16_f32 v58, v36, v37
    v_cvt_pk_bf16_f32 v59, v38, v39
    v_mfma_f32_32x32x8_bf16 v[16:31], v[144:145], v[138:139], v[16:31]
    ds_read_b64_tr_b16 v[162:163], v209 offset:1664
    v_exp_f32 v40, v40
    v_exp_f32 v41, v41
    v_exp_f32 v42, v42
    v_exp_f32 v43, v43
    v_cvt_pk_bf16_f32 v60, v40, v41
    v_cvt_pk_bf16_f32 v61, v42, v43
    v_mfma_f32_32x32x16_bf16 v[80:95], v[164:167], v[52:55], v[80:95]
    ds_read_b64_tr_b16 v[164:165], v209 offset:1792
    v_exp_f32 v44, v44
    v_exp_f32 v45, v45
    v_exp_f32 v46, v46
    v_exp_f32 v47, v47
    v_cvt_pk_bf16_f32 v62, v44, v45
    v_cvt_pk_bf16_f32 v63, v46, v47
    s_waitcnt lgkmcnt(5)
    v_mfma_f32_32x32x16_bf16 v[64:79], v[152:155], v[56:59], v[64:79]
    ds_read_b64_tr_b16 v[166:167], v209 offset:1920
    v_exp_f32 v16, v16
    v_exp_f32 v17, v17
    v_exp_f32 v18, v18
    v_exp_f32 v19, v19
    v_cvt_pk_bf16_f32 v48, v16, v17
    v_cvt_pk_bf16_f32 v49, v18, v19
    s_waitcnt lgkmcnt(4)
    v_mfma_f32_32x32x16_bf16 v[32:47], v[146:149], v[128:131], 0
    ds_read_b128 v[140:143], v207 offset:2048
    v_exp_f32 v20, v20
    v_exp_f32 v21, v21
    v_exp_f32 v22, v22
    v_exp_f32 v23, v23
    v_cvt_pk_bf16_f32 v50, v20, v21
    v_cvt_pk_bf16_f32 v51, v22, v23
    v_mfma_f32_32x32x8_bf16 v[32:47], v[150:151], v[132:133], v[32:47]
    ds_read_b64 v[144:145], v208 offset:2048
    v_exp_f32 v24, v24
    v_exp_f32 v25, v25
    v_exp_f32 v26, v26
    v_exp_f32 v27, v27
    v_cvt_pk_bf16_f32 v52, v24, v25
    v_cvt_pk_bf16_f32 v53, v26, v27
    v_mfma_f32_32x32x16_bf16 v[64:79], v[156:159], v[60:63], v[64:79]
    v_exp_f32 v28, v28
    v_exp_f32 v29, v29
    v_exp_f32 v30, v30
    v_exp_f32 v31, v31
    v_cvt_pk_bf16_f32 v54, v28, v29
    v_cvt_pk_bf16_f32 v55, v30, v31
    v_mfma_f32_32x32x16_bf16 v[80:95], v[152:155], v[48:51], v[80:95]
    v_exp_f32 v32, v32
    v_exp_f32 v33, v33
    v_exp_f32 v34, v34
    v_exp_f32 v35, v35
    v_cvt_pk_bf16_f32 v56, v32, v33
    v_cvt_pk_bf16_f32 v57, v34, v35
    v_mfma_f32_32x32x16_bf16 v[16:31], v[146:149], v[134:137], 0
    ds_read_b64_tr_b16 v[152:153], v209 offset:2048
    v_exp_f32 v36, v36
    v_exp_f32 v37, v37
    v_exp_f32 v38, v38
    v_exp_f32 v39, v39
    v_cvt_pk_bf16_f32 v58, v36, v37
    v_cvt_pk_bf16_f32 v59, v38, v39
    v_mfma_f32_32x32x8_bf16 v[16:31], v[150:151], v[138:139], v[16:31]
    ds_read_b64_tr_b16 v[154:155], v209 offset:2176
    v_exp_f32 v40, v40
    v_exp_f32 v41, v41
    v_exp_f32 v42, v42
    v_exp_f32 v43, v43
    v_cvt_pk_bf16_f32 v60, v40, v41
    v_cvt_pk_bf16_f32 v61, v42, v43
    v_mfma_f32_32x32x16_bf16 v[80:95], v[156:159], v[52:55], v[80:95]
    ds_read_b64_tr_b16 v[156:157], v209 offset:2304
    v_exp_f32 v44, v44
    v_exp_f32 v45, v45
    v_exp_f32 v46, v46
    v_exp_f32 v47, v47
    v_cvt_pk_bf16_f32 v62, v44, v45
    v_cvt_pk_bf16_f32 v63, v46, v47
    s_waitcnt lgkmcnt(5)
    v_mfma_f32_32x32x16_bf16 v[64:79], v[160:163], v[56:59], v[64:79]
    ds_read_b64_tr_b16 v[158:159], v209 offset:2432
    v_exp_f32 v16, v16
    v_exp_f32 v17, v17
    v_exp_f32 v18, v18
    v_exp_f32 v19, v19
    v_cvt_pk_bf16_f32 v48, v16, v17
    v_cvt_pk_bf16_f32 v49, v18, v19
    s_waitcnt lgkmcnt(4)
    v_mfma_f32_32x32x16_bf16 v[32:47], v[140:143], v[128:131], 0
    ds_read_b128 v[146:149], v207 offset:2560
    v_exp_f32 v20, v20
    v_exp_f32 v21, v21
    v_exp_f32 v22, v22
    v_exp_f32 v23, v23
    v_cvt_pk_bf16_f32 v50, v20, v21
    v_cvt_pk_bf16_f32 v51, v22, v23
    v_mfma_f32_32x32x8_bf16 v[32:47], v[144:145], v[132:133], v[32:47]
    ds_read_b64 v[150:151], v208 offset:2560
    v_exp_f32 v24, v24
    v_exp_f32 v25, v25
    v_exp_f32 v26, v26
    v_exp_f32 v27, v27
    v_cvt_pk_bf16_f32 v52, v24, v25
    v_cvt_pk_bf16_f32 v53, v26, v27
    v_mfma_f32_32x32x16_bf16 v[64:79], v[164:167], v[60:63], v[64:79]
    v_exp_f32 v28, v28
    v_exp_f32 v29, v29
    v_exp_f32 v30, v30
    v_exp_f32 v31, v31
    v_cvt_pk_bf16_f32 v54, v28, v29
    v_cvt_pk_bf16_f32 v55, v30, v31
    v_mfma_f32_32x32x16_bf16 v[80:95], v[160:163], v[48:51], v[80:95]
    v_exp_f32 v32, v32
    v_exp_f32 v33, v33
    v_exp_f32 v34, v34
    v_exp_f32 v35, v35
    v_cvt_pk_bf16_f32 v56, v32, v33
    v_cvt_pk_bf16_f32 v57, v34, v35
    v_mfma_f32_32x32x16_bf16 v[16:31], v[140:143], v[134:137], 0
    ds_read_b64_tr_b16 v[160:161], v209 offset:2560
    v_exp_f32 v36, v36
    v_exp_f32 v37, v37
    v_exp_f32 v38, v38
    v_exp_f32 v39, v39
    v_cvt_pk_bf16_f32 v58, v36, v37
    v_cvt_pk_bf16_f32 v59, v38, v39
    v_mfma_f32_32x32x8_bf16 v[16:31], v[144:145], v[138:139], v[16:31]
    ds_read_b64_tr_b16 v[162:163], v209 offset:2688
    v_exp_f32 v40, v40
    v_exp_f32 v41, v41
    v_exp_f32 v42, v42
    v_exp_f32 v43, v43
    v_cvt_pk_bf16_f32 v60, v40, v41
    v_cvt_pk_bf16_f32 v61, v42, v43
    v_mfma_f32_32x32x16_bf16 v[80:95], v[164:167], v[52:55], v[80:95]
    ds_read_b64_tr_b16 v[164:165], v209 offset:2816
    v_exp_f32 v44, v44
    v_exp_f32 v45, v45
    v_exp_f32 v46, v46
    v_exp_f32 v47, v47
    v_cvt_pk_bf16_f32 v62, v44, v45
    v_cvt_pk_bf16_f32 v63, v46, v47
    s_waitcnt lgkmcnt(5)
    v_mfma_f32_32x32x16_bf16 v[64:79], v[152:155], v[56:59], v[64:79]
    ds_read_b64_tr_b16 v[166:167], v209 offset:2944
    v_exp_f32 v16, v16
    v_exp_f32 v17, v17
    v_exp_f32 v18, v18
    v_exp_f32 v19, v19
    v_cvt_pk_bf16_f32 v48, v16, v17
    v_cvt_pk_bf16_f32 v49, v18, v19
    s_waitcnt lgkmcnt(4)
    v_mfma_f32_32x32x16_bf16 v[32:47], v[146:149], v[128:131], 0
    ds_read_b128 v[140:143], v207 offset:3072
    v_exp_f32 v20, v20
    v_exp_f32 v21, v21
    v_exp_f32 v22, v22
    v_exp_f32 v23, v23
    v_cvt_pk_bf16_f32 v50, v20, v21
    v_cvt_pk_bf16_f32 v51, v22, v23
    v_mfma_f32_32x32x8_bf16 v[32:47], v[150:151], v[132:133], v[32:47]
    ds_read_b64 v[144:145], v208 offset:3072
    v_exp_f32 v24, v24
    v_exp_f32 v25, v25
    v_exp_f32 v26, v26
    v_exp_f32 v27, v27
    v_cvt_pk_bf16_f32 v52, v24, v25
    v_cvt_pk_bf16_f32 v53, v26, v27
    v_mfma_f32_32x32x16_bf16 v[64:79], v[156:159], v[60:63], v[64:79]
    v_exp_f32 v28, v28
    v_exp_f32 v29, v29
    v_exp_f32 v30, v30
    v_exp_f32 v31, v31
    v_cvt_pk_bf16_f32 v54, v28, v29
    v_cvt_pk_bf16_f32 v55, v30, v31
    v_mfma_f32_32x32x16_bf16 v[80:95], v[152:155], v[48:51], v[80:95]
    v_exp_f32 v32, v32
    v_exp_f32 v33, v33
    v_exp_f32 v34, v34
    v_exp_f32 v35, v35
    v_cvt_pk_bf16_f32 v56, v32, v33
    v_cvt_pk_bf16_f32 v57, v34, v35
    v_mfma_f32_32x32x16_bf16 v[16:31], v[146:149], v[134:137], 0
    ds_read_b64_tr_b16 v[152:153], v209 offset:3072
    v_exp_f32 v36, v36
    v_exp_f32 v37, v37
    v_exp_f32 v38, v38
    v_exp_f32 v39, v39
    v_cvt_pk_bf16_f32 v58, v36, v37
    v_cvt_pk_bf16_f32 v59, v38, v39
    v_mfma_f32_32x32x8_bf16 v[16:31], v[150:151], v[138:139], v[16:31]
    ds_read_b64_tr_b16 v[154:155], v209 offset:3200
    v_exp_f32 v40, v40
    v_exp_f32 v41, v41
    v_exp_f32 v42, v42
    v_exp_f32 v43, v43
    v_cvt_pk_bf16_f32 v60, v40, v41
    v_cvt_pk_bf16_f32 v61, v42, v43
    v_mfma_f32_32x32x16_bf16 v[80:95], v[156:159], v[52:55], v[80:95]
    ds_read_b64_tr_b16 v[156:157], v209 offset:3328
    v_exp_f32 v44, v44
    v_exp_f32 v45, v45
    v_exp_f32 v46, v46
    v_exp_f32 v47, v47
    v_cvt_pk_bf16_f32 v62, v44, v45
    v_cvt_pk_bf16_f32 v63, v46, v47
    s_waitcnt lgkmcnt(5)
    v_mfma_f32_32x32x16_bf16 v[64:79], v[160:163], v[56:59], v[64:79]
    ds_read_b64_tr_b16 v[158:159], v209 offset:3456
    v_exp_f32 v16, v16
    v_exp_f32 v17, v17
    v_exp_f32 v18, v18
    v_exp_f32 v19, v19
    v_cvt_pk_bf16_f32 v48, v16, v17
    v_cvt_pk_bf16_f32 v49, v18, v19
    s_waitcnt lgkmcnt(4)
    v_mfma_f32_32x32x16_bf16 v[32:47], v[140:143], v[128:131], 0
    ds_read_b128 v[146:149], v207 offset:3584
    v_exp_f32 v20, v20
    v_exp_f32 v21, v21
    v_exp_f32 v22, v22
    v_exp_f32 v23, v23
    v_cvt_pk_bf16_f32 v50, v20, v21
    v_cvt_pk_bf16_f32 v51, v22, v23
    v_mfma_f32_32x32x8_bf16 v[32:47], v[144:145], v[132:133], v[32:47]
    ds_read_b64 v[150:151], v208 offset:3584
    v_exp_f32 v24, v24
    v_exp_f32 v25, v25
    v_exp_f32 v26, v26
    v_exp_f32 v27, v27
    v_cvt_pk_bf16_f32 v52, v24, v25
    v_cvt_pk_bf16_f32 v53, v26, v27
    v_mfma_f32_32x32x16_bf16 v[64:79], v[164:167], v[60:63], v[64:79]
    v_exp_f32 v28, v28
    v_exp_f32 v29, v29
    v_exp_f32 v30, v30
    v_exp_f32 v31, v31
    v_cvt_pk_bf16_f32 v54, v28, v29
    v_cvt_pk_bf16_f32 v55, v30, v31
    v_mfma_f32_32x32x16_bf16 v[80:95], v[160:163], v[48:51], v[80:95]
    v_exp_f32 v32, v32
    v_exp_f32 v33, v33
    v_exp_f32 v34, v34
    v_exp_f32 v35, v35
    v_cvt_pk_bf16_f32 v56, v32, v33
    v_cvt_pk_bf16_f32 v57, v34, v35
    v_mfma_f32_32x32x16_bf16 v[16:31], v[140:143], v[134:137], 0
    ds_read_b64_tr_b16 v[160:161], v209 offset:3584
    v_exp_f32 v36, v36
    v_exp_f32 v37, v37
    v_exp_f32 v38, v38
    v_exp_f32 v39, v39
    v_cvt_pk_bf16_f32 v58, v36, v37
    v_cvt_pk_bf16_f32 v59, v38, v39
    v_mfma_f32_32x32x8_bf16 v[16:31], v[144:145], v[138:139], v[16:31]
    ds_read_b64_tr_b16 v[162:163], v209 offset:3712
    v_exp_f32 v40, v40
    v_exp_f32 v41, v41
    v_exp_f32 v42, v42
    v_exp_f32 v43, v43
    v_cvt_pk_bf16_f32 v60, v40, v41
    v_cvt_pk_bf16_f32 v61, v42, v43
    v_mfma_f32_32x32x16_bf16 v[80:95], v[164:167], v[52:55], v[80:95]
    ds_read_b64_tr_b16 v[164:165], v209 offset:3840
    v_exp_f32 v44, v44
    v_exp_f32 v45, v45
    v_exp_f32 v46, v46
    v_exp_f32 v47, v47
    v_cvt_pk_bf16_f32 v62, v44, v45
    v_cvt_pk_bf16_f32 v63, v46, v47
    s_waitcnt lgkmcnt(5)
    v_mfma_f32_32x32x16_bf16 v[64:79], v[152:155], v[56:59], v[64:79]
    ds_read_b64_tr_b16 v[166:167], v209 offset:3968
    v_exp_f32 v16, v16
    v_exp_f32 v17, v17
    v_exp_f32 v18, v18
    v_exp_f32 v19, v19
    v_cvt_pk_bf16_f32 v48, v16, v17
    v_cvt_pk_bf16_f32 v49, v18, v19
    s_waitcnt lgkmcnt(4)
    v_mfma_f32_32x32x16_bf16 v[32:47], v[146:149], v[128:131], 0
    ds_read_b128 v[140:143], v207 offset:4096
    v_exp_f32 v20, v20
    v_exp_f32 v21, v21
    v_exp_f32 v22, v22
    v_exp_f32 v23, v23
    v_cvt_pk_bf16_f32 v50, v20, v21
    v_cvt_pk_bf16_f32 v51, v22, v23
    v_mfma_f32_32x32x8_bf16 v[32:47], v[150:151], v[132:133], v[32:47]
    ds_read_b64 v[144:145], v208 offset:4096
    v_exp_f32 v24, v24
    v_exp_f32 v25, v25
    v_exp_f32 v26, v26
    v_exp_f32 v27, v27
    v_cvt_pk_bf16_f32 v52, v24, v25
    v_cvt_pk_bf16_f32 v53, v26, v27
    v_mfma_f32_32x32x16_bf16 v[64:79], v[156:159], v[60:63], v[64:79]
    v_exp_f32 v28, v28
    v_exp_f32 v29, v29
    v_exp_f32 v30, v30
    v_exp_f32 v31, v31
    v_cvt_pk_bf16_f32 v54, v28, v29
    v_cvt_pk_bf16_f32 v55, v30, v31
    v_mfma_f32_32x32x16_bf16 v[80:95], v[152:155], v[48:51], v[80:95]
    v_exp_f32 v32, v32
    v_exp_f32 v33, v33
    v_exp_f32 v34, v34
    v_exp_f32 v35, v35
    v_cvt_pk_bf16_f32 v56, v32, v33
    v_cvt_pk_bf16_f32 v57, v34, v35
    v_mfma_f32_32x32x16_bf16 v[16:31], v[146:149], v[134:137], 0
    ds_read_b64_tr_b16 v[152:153], v209 offset:4096
    v_exp_f32 v36, v36
    v_exp_f32 v37, v37
    v_exp_f32 v38, v38
    v_exp_f32 v39, v39
    v_cvt_pk_bf16_f32 v58, v36, v37
    v_cvt_pk_bf16_f32 v59, v38, v39
    v_mfma_f32_32x32x8_bf16 v[16:31], v[150:151], v[138:139], v[16:31]
    ds_read_b64_tr_b16 v[154:155], v209 offset:4224
    v_exp_f32 v40, v40
    v_exp_f32 v41, v41
    v_exp_f32 v42, v42
    v_exp_f32 v43, v43
    v_cvt_pk_bf16_f32 v60, v40, v41
    v_cvt_pk_bf16_f32 v61, v42, v43
    v_mfma_f32_32x32x16_bf16 v[80:95], v[156:159], v[52:55], v[80:95]
    ds_read_b64_tr_b16 v[156:157], v209 offset:4352
    v_exp_f32 v44, v44
    v_exp_f32 v45, v45
    v_exp_f32 v46, v46
    v_exp_f32 v47, v47
    v_cvt_pk_bf16_f32 v62, v44, v45
    v_cvt_pk_bf16_f32 v63, v46, v47
    s_waitcnt lgkmcnt(5)
    v_mfma_f32_32x32x16_bf16 v[64:79], v[160:163], v[56:59], v[64:79]
    ds_read_b64_tr_b16 v[158:159], v209 offset:4480
    v_exp_f32 v16, v16
    v_exp_f32 v17, v17
    v_exp_f32 v18, v18
    v_exp_f32 v19, v19
    v_cvt_pk_bf16_f32 v48, v16, v17
    v_cvt_pk_bf16_f32 v49, v18, v19
    s_waitcnt lgkmcnt(4)
    v_mfma_f32_32x32x16_bf16 v[32:47], v[140:143], v[128:131], v[96:111]
    ds_read_b128 v[146:149], v207 offset:4608
    v_exp_f32 v20, v20
    v_exp_f32 v21, v21
    v_exp_f32 v22, v22
    v_exp_f32 v23, v23
    v_cvt_pk_bf16_f32 v50, v20, v21
    v_cvt_pk_bf16_f32 v51, v22, v23
    v_mfma_f32_32x32x8_bf16 v[32:47], v[144:145], v[132:133], v[32:47]
    ds_read_b64 v[150:151], v208 offset:4608
    v_exp_f32 v24, v24
    v_exp_f32 v25, v25
    v_exp_f32 v26, v26
    v_exp_f32 v27, v27
    v_cvt_pk_bf16_f32 v52, v24, v25
    v_cvt_pk_bf16_f32 v53, v26, v27
    v_mfma_f32_32x32x16_bf16 v[64:79], v[164:167], v[60:63], v[64:79]
    v_exp_f32 v28, v28
    v_exp_f32 v29, v29
    v_exp_f32 v30, v30
    v_exp_f32 v31, v31
    v_cvt_pk_bf16_f32 v54, v28, v29
    v_cvt_pk_bf16_f32 v55, v30, v31
    v_mfma_f32_32x32x16_bf16 v[80:95], v[160:163], v[48:51], v[80:95]
    v_exp_f32 v32, v32
    v_exp_f32 v33, v33
    v_exp_f32 v34, v34
    v_exp_f32 v35, v35
    v_cvt_pk_bf16_f32 v56, v32, v33
    v_cvt_pk_bf16_f32 v57, v34, v35
    v_mfma_f32_32x32x16_bf16 v[16:31], v[140:143], v[134:137], 0
    ds_read_b64_tr_b16 v[160:161], v209 offset:4608
    v_exp_f32 v36, v36
    v_exp_f32 v37, v37
    v_exp_f32 v38, v38
    v_exp_f32 v39, v39
    v_cvt_pk_bf16_f32 v58, v36, v37
    v_cvt_pk_bf16_f32 v59, v38, v39
    v_mfma_f32_32x32x8_bf16 v[16:31], v[144:145], v[138:139], v[16:31]
    ds_read_b64_tr_b16 v[162:163], v209 offset:4736
    v_exp_f32 v40, v40
    v_exp_f32 v41, v41
    v_exp_f32 v42, v42
    v_exp_f32 v43, v43
    v_cvt_pk_bf16_f32 v60, v40, v41
    v_cvt_pk_bf16_f32 v61, v42, v43
    v_mfma_f32_32x32x16_bf16 v[80:95], v[164:167], v[52:55], v[80:95]
    ds_read_b64_tr_b16 v[164:165], v209 offset:4864
    v_exp_f32 v44, v44
    v_exp_f32 v45, v45
    v_exp_f32 v46, v46
    v_exp_f32 v47, v47
    v_cvt_pk_bf16_f32 v62, v44, v45
    v_cvt_pk_bf16_f32 v63, v46, v47
    s_waitcnt lgkmcnt(5)
    v_mfma_f32_32x32x16_bf16 v[64:79], v[152:155], v[56:59], v[64:79]
    ds_read_b64_tr_b16 v[166:167], v209 offset:4992
    v_exp_f32 v16, v16
    v_exp_f32 v17, v17
    v_exp_f32 v18, v18
    v_exp_f32 v19, v19
    v_cvt_pk_bf16_f32 v48, v16, v17
    v_cvt_pk_bf16_f32 v49, v18, v19
    s_waitcnt lgkmcnt(4)
    v_mfma_f32_32x32x16_bf16 v[32:47], v[146:149], v[134:137], v[96:111]
    v_exp_f32 v20, v20
    v_exp_f32 v21, v21
    v_exp_f32 v22, v22
    v_exp_f32 v23, v23
    v_cvt_pk_bf16_f32 v50, v20, v21
    v_cvt_pk_bf16_f32 v51, v22, v23
    v_mfma_f32_32x32x8_bf16 v[32:47], v[150:151], v[138:139], v[32:47]
    v_exp_f32 v24, v24
    v_exp_f32 v25, v25
    v_exp_f32 v26, v26
    v_exp_f32 v27, v27
    v_cvt_pk_bf16_f32 v52, v24, v25
    v_cvt_pk_bf16_f32 v53, v26, v27
    v_mfma_f32_32x32x16_bf16 v[64:79], v[156:159], v[60:63], v[64:79]
    v_exp_f32 v28, v28
    v_exp_f32 v29, v29
    v_exp_f32 v30, v30
    v_exp_f32 v31, v31
    v_cvt_pk_bf16_f32 v54, v28, v29
    v_cvt_pk_bf16_f32 v55, v30, v31
    v_mfma_f32_32x32x16_bf16 v[80:95], v[152:155], v[48:51], v[80:95]
    v_exp_f32 v32, v32
    v_exp_f32 v33, v33
    v_exp_f32 v34, v34
    v_exp_f32 v35, v35
    v_cvt_pk_bf16_f32 v56, v32, v33
    v_cvt_pk_bf16_f32 v57, v34, v35
    v_exp_f32 v36, v36
    v_exp_f32 v37, v37
    v_exp_f32 v38, v38
    v_exp_f32 v39, v39
    v_cvt_pk_bf16_f32 v58, v36, v37
    v_cvt_pk_bf16_f32 v59, v38, v39
    v_exp_f32 v40, v40
    v_exp_f32 v41, v41
    v_exp_f32 v42, v42
    v_exp_f32 v43, v43
    v_cvt_pk_bf16_f32 v60, v40, v41
    v_cvt_pk_bf16_f32 v61, v42, v43
    v_mfma_f32_32x32x16_bf16 v[80:95], v[156:159], v[52:55], v[80:95]
    v_exp_f32 v44, v44
    v_exp_f32 v45, v45
    v_exp_f32 v46, v46
    v_exp_f32 v47, v47
    v_cvt_pk_bf16_f32 v62, v44, v45
    v_cvt_pk_bf16_f32 v63, v46, v47
    s_waitcnt lgkmcnt(0)
    v_mfma_f32_32x32x16_bf16 v[80:95], v[160:163], v[56:59], v[80:95]
    v_mfma_f32_32x32x16_bf16 v[80:95], v[164:167], v[60:63], v[80:95]
    s_mov_b32 s66, 0x30800000
    s_mov_b32 s67, 0x4e800000
    s_add_u32 s9, s54, s55
    v_pk_mul_f32 v[254:255], v[64:65], 0 op_sel_hi:[1,0]
    v_pk_fma_f32 v[254:255], v[66:67], 0, v[254:255] op_sel_hi:[1,0,1]
    v_pk_fma_f32 v[254:255], v[68:69], 0, v[254:255] op_sel_hi:[1,0,1]
    v_pk_fma_f32 v[254:255], v[70:71], 0, v[254:255] op_sel_hi:[1,0,1]
    v_pk_fma_f32 v[254:255], v[72:73], 0, v[254:255] op_sel_hi:[1,0,1]
    v_pk_fma_f32 v[254:255], v[74:75], 0, v[254:255] op_sel_hi:[1,0,1]
    s_nop 2
    v_pk_fma_f32 v[254:255], v[80:81], 0, v[254:255] op_sel_hi:[1,0,1]
    v_pk_fma_f32 v[254:255], v[82:83], 0, v[254:255] op_sel_hi:[1,0,1]
    v_pk_fma_f32 v[254:255], v[84:85], 0, v[254:255] op_sel_hi:[1,0,1]
    v_pk_fma_f32 v[254:255], v[86:87], 0, v[254:255] op_sel_hi:[1,0,1]
    v_pk_fma_f32 v[254:255], v[88:89], 0, v[254:255] op_sel_hi:[1,0,1]
    v_pk_fma_f32 v[254:255], v[90:91], 0, v[254:255] op_sel_hi:[1,0,1]
    v_cmp_nle_f32 vcc, s66, v76
    v_cmp_nle_f32 s[70:71], s66, v92
    v_max_f32 v253, v76, v92
    s_or_b64 vcc, vcc, s[70:71]
    v_cmp_u_f32 s[70:71], v254, v255
    v_cmp_nge_f32 s[72:73], s67, v253
    s_or_b64 vcc, vcc, s[70:71]
    s_or_b64 vcc, vcc, s[72:73]
    s_cbranch_scc1 .La_slow
.La_norm:
    v_rcp_f32 v250, v76
    v_rcp_f32 v252, v92
    v_pk_mul_f32 v[64:65], v[64:65], v[250:251] op_sel_hi:[1,0]
    v_pk_mul_f32 v[66:67], v[66:67], v[250:251] op_sel_hi:[1,0]
    v_pk_mul_f32 v[68:69], v[68:69], v[250:251] op_sel_hi:[1,0]
    v_pk_mul_f32 v[70:71], v[70:71], v[250:251] op_sel_hi:[1,0]
    v_pk_mul_f32 v[72:73], v[72:73], v[250:251] op_sel_hi:[1,0]
    v_pk_mul_f32 v[74:75], v[74:75], v[250:251] op_sel_hi:[1,0]
    v_cvt_pk_bf16_f32 v64, v64, v65
    v_cvt_pk_bf16_f32 v65, v66, v67
    v_cvt_pk_bf16_f32 v66, v68, v69
    v_cvt_pk_bf16_f32 v67, v70, v71
    v_cvt_pk_bf16_f32 v68, v72, v73
    v_cvt_pk_bf16_f32 v69, v74, v75
    v_pk_mul_f32 v[80:81], v[80:81], v[252:253] op_sel_hi:[1,0]
    v_pk_mul_f32 v[82:83], v[82:83], v[252:253] op_sel_hi:[1,0]
    v_pk_mul_f32 v[84:85], v[84:85], v[252:253] op_sel_hi:[1,0]
    v_pk_mul_f32 v[86:87], v[86:87], v[252:253] op_sel_hi:[1,0]
    v_pk_mul_f32 v[88:89], v[88:89], v[252:253] op_sel_hi:[1,0]
    v_pk_mul_f32 v[90:91], v[90:91], v[252:253] op_sel_hi:[1,0]
    v_cvt_pk_bf16_f32 v80, v80, v81
    v_cvt_pk_bf16_f32 v81, v82, v83
    v_cvt_pk_bf16_f32 v82, v84, v85
    v_cvt_pk_bf16_f32 v83, v86, v87
    v_cvt_pk_bf16_f32 v84, v88, v89
    v_cvt_pk_bf16_f32 v85, v90, v91
    v_permlane32_swap_b32 v64, v66
    v_permlane32_swap_b32 v65, v67
    v_permlane32_swap_b32 v80, v82
    v_permlane32_swap_b32 v81, v83
    v_permlane32_swap_b32 v68, v84
    v_permlane32_swap_b32 v69, v85
    s_cmp_eq_u32 s75, 1
    s_cbranch_scc0 .Ldg_40
    buffer_store_dwordx4 v[64:67], v203, s[48:51], 0 offen
    buffer_store_dwordx4 v[80:83], v203, s[48:51], 0 offen offset:512
    buffer_store_dwordx2 v[68:69], v206, s[48:51], s9 offen
.Ldd_41:
    s_mov_b32 s56, s34
    s_mov_b32 s57, s35
    s_mov_b32 s58, 5242880
    s_mov_b32 s59, 0x20000
    s_and_b32 s10, s5, 7
    s_lshr_b32 s11, s5, 3
    s_lshl_b32 s66, s4, 2
    s_add_u32 s66, s66, s11
    s_lshl_b32 s67, s66, 12
    s_add_u32 s67, s67, 15073280
    v_lshl_add_u32 v2, v7, 7, s67
    s_lshl_b32 s66, s66, 2
    s_add_u32 s66, s66, s3
    s_lshl_b32 s12, s66, 4
    v_and_b32 v9, 15, v0
    v_lshrrev_b32 v10, 4, v0
    v_add_u32 v9, s12, v9
    v_mul_u32_u24 v3, 32768, v10
    v_lshl_add_u32 v3, v9, 4, v3
    v_add_u32 v6, 100864, v206
    v_add_u32 v5, 49664, v206
    s_lshl_b32 s66, s4, 2
    s_add_u32 s66, s66, s3
    s_lshl_b32 s66, s66, 5
    s_add_u32 s66, s66, s5
    s_lshl_b32 s66, s66, 7
    s_add_u32 s66, s66, 15073280
    s_waitcnt vmcnt(0)
    v_mov_b32 v250, s64
    v_mov_b32 v251, s65
    v_mov_b32 v252, 0
    v_mov_b32 v253, 0
    v_lshlrev_b32 v254, 4, v0
    s_mov_b64 exec, 0xff
    s_cmp_eq_u32 s75, 1
    s_cbranch_scc0 .Ldg_42
    buffer_store_dwordx4 v[250:253], v254, s[48:51], s66 offen
.Ldd_43:
    s_mov_b64 exec, -1
    s_nop 0
    v_mov_b32 v250, 163588
    s_mov_b32 s74, 65536
.Llw_44:
    ds_read_b32 v251, v250
    s_waitcnt lgkmcnt(0)
    v_readfirstlane_b32 s72, v251
    s_nop 0
    s_cmp_ge_u32 s72, 4
    s_cbranch_scc1 .Llwd_45
    s_sleep 1
    s_sub_u32 s74, s74, 1
    s_cbranch_scc0 .Llw_44
.Llwd_45:
    ds_read_b128 v[112:115], v5 offset:0
    ds_read_b128 v[116:119], v5 offset:1024
    ds_read_b128 v[120:123], v5 offset:2048
    ds_read_b128 v[124:127], v5 offset:3072
    ds_read_b128 v[128:131], v5 offset:4096
    ds_read_b128 v[132:135], v5 offset:5120
    ds_read_b128 v[136:139], v5 offset:6144
    ds_read_b128 v[140:143], v5 offset:7168
    ds_read_b128 v[144:147], v5 offset:8192
    ds_read_b128 v[148:151], v5 offset:9216
    ds_read_b128 v[152:155], v5 offset:10240
    ds_read_b128 v[156:159], v5 offset:11264
    ds_read_b128 v[160:163], v5 offset:12288
    ds_read_b128 v[164:167], v5 offset:13312
    ds_read_b128 v[168:171], v5 offset:14336
    ds_read_b128 v[172:175], v5 offset:15360
    s_mov_b32 s74, 16384
    s_mov_b64 exec, 0xffffffff
.Lpoll_46:
    buffer_load_dwordx2 v[250:251], v2, s[48:51], 0 offen sc1
    s_waitcnt vmcnt(0)
    v_cmp_ne_u64 vcc, s[64:65], v[250:251]
    s_nop 0
    s_and_b64 exec, exec, vcc
    s_cbranch_scc0 .Lpolld_47
    s_sub_u32 s74, s74, 1
    s_cbranch_scc0 .Lpoll_46
.Lpolld_47:
    s_mov_b64 exec, -1
    s_mov_b32 s66, 0
    buffer_load_dwordx4 v[12:15], v3, s[48:51], s66 offen sc1
    s_add_u32 s66, s66, 131072
    buffer_load_dwordx4 v[16:19], v3, s[48:51], s66 offen sc1
    s_add_u32 s66, s66, 131072
    buffer_load_dwordx4 v[20:23], v3, s[48:51], s66 offen sc1
    s_add_u32 s66, s66, 131072
    buffer_load_dwordx4 v[24:27], v3, s[48:51], s66 offen sc1
    s_add_u32 s66, s66, 131072
    buffer_load_dwordx4 v[28:31], v3, s[48:51], s66 offen sc1
    s_add_u32 s66, s66, 131072
    buffer_load_dwordx4 v[32:35], v3, s[48:51], s66 offen sc1
    s_add_u32 s66, s66, 131072
    ds_read_b128 v[176:179], v5 offset:16384
    ds_read_b128 v[180:183], v5 offset:17408
    ds_read_b128 v[184:187], v5 offset:18432
    ds_read_b128 v[188:191], v5 offset:19456
    ds_read_b128 v[192:195], v5 offset:20480
    ds_read_b128 v[196:199], v5 offset:21504
    ds_read_b128 v[200:203], v5 offset:22528
    ds_read_b128 v[204:207], v5 offset:23552
    ds_read_b128 v[208:211], v5 offset:24576
    ds_read_b128 v[212:215], v5 offset:25600
    ds_read_b128 v[216:219], v5 offset:26624
    ds_read_b128 v[220:223], v5 offset:27648
    ds_read_b128 v[224:227], v5 offset:28672
    ds_read_b128 v[228:231], v5 offset:29696
    ds_read_b128 v[232:235], v5 offset:30720
    ds_read_b128 v[236:239], v5 offset:31744
    s_waitcnt vmcnt(5)
    s_waitcnt lgkmcnt(15)
    v_mfma_f32_16x16x32_bf16 v[92:95], v[112:115], v[12:15], 0
    ds_read_b128 v[240:243], v5 offset:32768
    v_mfma_f32_16x16x32_bf16 v[96:99], v[116:119], v[12:15], 0
    ds_read_b128 v[112:115], v5 offset:33792
    v_mfma_f32_16x16x32_bf16 v[100:103], v[120:123], v[12:15], 0
    ds_read_b128 v[116:119], v5 offset:34816
    v_mfma_f32_16x16x32_bf16 v[104:107], v[124:127], v[12:15], 0
    ds_read_b128 v[120:123], v5 offset:35840
    v_mfma_f32_16x16x32_bf16 v[108:111], v[128:131], v[12:15], 0
    buffer_load_dwordx4 v[36:39], v3, s[48:51], s66 offen sc1
    s_add_u32 s66, s66, 131072
    s_waitcnt vmcnt(5)
    v_mfma_f32_16x16x32_bf16 v[92:95], v[132:135], v[16:19], v[92:95]
    ds_read_b128 v[124:127], v5 offset:36864
    v_mfma_f32_16x16x32_bf16 v[96:99], v[136:139], v[16:19], v[96:99]
    ds_read_b128 v[128:131], v5 offset:37888
    v_mfma_f32_16x16x32_bf16 v[100:103], v[140:143], v[16:19], v[100:103]
    ds_read_b128 v[132:135], v5 offset:38912
    v_mfma_f32_16x16x32_bf16 v[104:107], v[144:147], v[16:19], v[104:107]
    ds_read_b128 v[136:139], v5 offset:39936
    v_mfma_f32_16x16x32_bf16 v[108:111], v[148:151], v[16:19], v[108:111]
    buffer_load_dwordx4 v[40:43], v3, s[48:51], s66 offen sc1
    s_add_u32 s66, s66, 131072
    s_waitcnt vmcnt(5)
    v_mfma_f32_16x16x32_bf16 v[92:95], v[152:155], v[20:23], v[92:95]
    ds_read_b128 v[140:143], v5 offset:40960
    v_mfma_f32_16x16x32_bf16 v[96:99], v[156:159], v[20:23], v[96:99]
    ds_read_b128 v[144:147], v5 offset:41984
    v_mfma_f32_16x16x32_bf16 v[100:103], v[160:163], v[20:23], v[100:103]
    ds_read_b128 v[148:151], v5 offset:43008
    v_mfma_f32_16x16x32_bf16 v[104:107], v[164:167], v[20:23], v[104:107]
    ds_read_b128 v[152:155], v5 offset:44032
    v_mfma_f32_16x16x32_bf16 v[108:111], v[168:171], v[20:23], v[108:111]
    buffer_load_dwordx4 v[44:47], v3, s[48:51], s66 offen sc1
    s_add_u32 s66, s66, 131072
    s_waitcnt vmcnt(5)
    s_waitcnt lgkmcnt(15)
    v_mfma_f32_16x16x32_bf16 v[92:95], v[172:175], v[24:27], v[92:95]
    ds_read_b128 v[156:159], v5 offset:45056
    v_mfma_f32_16x16x32_bf16 v[96:99], v[176:179], v[24:27], v[96:99]
    ds_read_b128 v[160:163], v5 offset:46080
    v_mfma_f32_16x16x32_bf16 v[100:103], v[180:183], v[24:27], v[100:103]
    ds_read_b128 v[164:167], v5 offset:47104
    v_mfma_f32_16x16x32_bf16 v[104:107], v[184:187], v[24:27], v[104:107]
    ds_read_b128 v[168:171], v5 offset:48128
    v_mfma_f32_16x16x32_bf16 v[108:111], v[188:191], v[24:27], v[108:111]
    buffer_load_dwordx4 v[48:51], v3, s[48:51], s66 offen sc1
    s_add_u32 s66, s66, 131072
    s_waitcnt vmcnt(5)
    v_mfma_f32_16x16x32_bf16 v[92:95], v[192:195], v[28:31], v[92:95]
    ds_read_b128 v[172:175], v5 offset:49152
    v_mfma_f32_16x16x32_bf16 v[96:99], v[196:199], v[28:31], v[96:99]
    ds_read_b128 v[176:179], v5 offset:50176
    v_mfma_f32_16x16x32_bf16 v[100:103], v[200:203], v[28:31], v[100:103]
    ds_read_b128 v[180:183], v6 offset:0
    v_mfma_f32_16x16x32_bf16 v[104:107], v[204:207], v[28:31], v[104:107]
    ds_read_b128 v[184:187], v6 offset:1024
    v_mfma_f32_16x16x32_bf16 v[108:111], v[208:211], v[28:31], v[108:111]
    buffer_load_dwordx4 v[52:55], v3, s[48:51], s66 offen sc1
    s_add_u32 s66, s66, 131072
    s_waitcnt vmcnt(5)
    s_waitcnt lgkmcnt(15)
    v_mfma_f32_16x16x32_bf16 v[92:95], v[212:215], v[32:35], v[92:95]
    ds_read_b128 v[188:191], v6 offset:2048
    v_mfma_f32_16x16x32_bf16 v[96:99], v[216:219], v[32:35], v[96:99]
    ds_read_b128 v[192:195], v6 offset:3072
    v_mfma_f32_16x16x32_bf16 v[100:103], v[220:223], v[32:35], v[100:103]
    ds_read_b128 v[196:199], v6 offset:4096
    v_mfma_f32_16x16x32_bf16 v[104:107], v[224:227], v[32:35], v[104:107]
    ds_read_b128 v[200:203], v6 offset:5120
    v_mfma_f32_16x16x32_bf16 v[108:111], v[228:231], v[32:35], v[108:111]
    buffer_load_dwordx4 v[56:59], v3, s[48:51], s66 offen sc1
    s_add_u32 s66, s66, 131072
    s_waitcnt vmcnt(5)
    v_mfma_f32_16x16x32_bf16 v[92:95], v[232:235], v[36:39], v[92:95]
    ds_read_b128 v[204:207], v6 offset:6144
    v_mfma_f32_16x16x32_bf16 v[96:99], v[236:239], v[36:39], v[96:99]
    ds_read_b128 v[208:211], v6 offset:7168
    v_mfma_f32_16x16x32_bf16 v[100:103], v[240:243], v[36:39], v[100:103]
    ds_read_b128 v[212:215], v6 offset:8192
    v_mfma_f32_16x16x32_bf16 v[104:107], v[112:115], v[36:39], v[104:107]
    ds_read_b128 v[216:219], v6 offset:9216
    v_mfma_f32_16x16x32_bf16 v[108:111], v[116:119], v[36:39], v[108:111]
    buffer_load_dwordx4 v[60:63], v3, s[48:51], s66 offen sc1
    s_add_u32 s66, s66, 131072
    s_waitcnt vmcnt(5)
    s_waitcnt lgkmcnt(15)
    v_mfma_f32_16x16x32_bf16 v[92:95], v[120:123], v[40:43], v[92:95]
    ds_read_b128 v[220:223], v6 offset:10240
    v_mfma_f32_16x16x32_bf16 v[96:99], v[124:127], v[40:43], v[96:99]
    ds_read_b128 v[224:227], v6 offset:11264
    v_mfma_f32_16x16x32_bf16 v[100:103], v[128:131], v[40:43], v[100:103]
    ds_read_b128 v[228:231], v6 offset:12288
    v_mfma_f32_16x16x32_bf16 v[104:107], v[132:135], v[40:43], v[104:107]
    ds_read_b128 v[232:235], v6 offset:13312
    v_mfma_f32_16x16x32_bf16 v[108:111], v[136:139], v[40:43], v[108:111]
    buffer_load_dwordx4 v[64:67], v3, s[48:51], s66 offen sc1
    s_add_u32 s66, s66, 131072
    s_waitcnt vmcnt(5)
    v_mfma_f32_16x16x32_bf16 v[92:95], v[140:143], v[44:47], v[92:95]
    ds_read_b128 v[236:239], v6 offset:14336
    v_mfma_f32_16x16x32_bf16 v[96:99], v[144:147], v[44:47], v[96:99]
    ds_read_b128 v[240:243], v6 offset:15360
    v_mfma_f32_16x16x32_bf16 v[100:103], v[148:151], v[44:47], v[100:103]
    ds_read_b128 v[112:115], v6 offset:16384
    v_mfma_f32_16x16x32_bf16 v[104:107], v[152:155], v[44:47], v[104:107]
    ds_read_b128 v[116:119], v6 offset:17408
    v_mfma_f32_16x16x32_bf16 v[108:111], v[156:159], v[44:47], v[108:111]
    buffer_load_dwordx4 v[68:71], v3, s[48:51], s66 offen sc1
    s_add_u32 s66, s66, 131072
    s_waitcnt vmcnt(5)
    s_waitcnt lgkmcnt(15)
    v_mfma_f32_16x16x32_bf16 v[92:95], v[160:163], v[48:51], v[92:95]
    ds_read_b128 v[120:123], v6 offset:18432
    v_mfma_f32_16x16x32_bf16 v[96:99], v[164:167], v[48:51], v[96:99]
    ds_read_b128 v[124:127], v6 offset:19456
    v_mfma_f32_16x16x32_bf16 v[100:103], v[168:171], v[48:51], v[100:103]
    ds_read_b128 v[128:131], v6 offset:20480
    v_mfma_f32_16x16x32_bf16 v[104:107], v[172:175], v[48:51], v[104:107]
    ds_read_b128 v[132:135], v6 offset:21504
    v_mfma_f32_16x16x32_bf16 v[108:111], v[176:179], v[48:51], v[108:111]
    buffer_load_dwordx4 v[72:75], v3, s[48:51], s66 offen sc1
    s_add_u32 s66, s66, 131072
    s_waitcnt vmcnt(5)
    s_waitcnt lgkmcnt(15)
    v_mfma_f32_16x16x32_bf16 v[92:95], v[180:183], v[52:55], v[92:95]
    ds_read_b128 v[136:139], v6 offset:22528
    v_mfma_f32_16x16x32_bf16 v[96:99], v[184:187], v[52:55], v[96:99]
    ds_read_b128 v[140:143], v6 offset:23552
    v_mfma_f32_16x16x32_bf16 v[100:103], v[188:191], v[52:55], v[100:103]
    ds_read_b128 v[144:147], v6 offset:24576
    v_mfma_f32_16x16x32_bf16 v[104:107], v[192:195], v[52:55], v[104:107]
    ds_read_b128 v[148:151], v6 offset:25600
    v_mfma_f32_16x16x32_bf16 v[108:111], v[196:199], v[52:55], v[108:111]
    buffer_load_dwordx4 v[76:79], v3, s[48:51], s66 offen sc1
    s_add_u32 s66, s66, 131072
    s_waitcnt vmcnt(5)
    s_waitcnt lgkmcnt(15)
    v_mfma_f32_16x16x32_bf16 v[92:95], v[200:203], v[56:59], v[92:95]
    ds_read_b128 v[152:155], v6 offset:26624
    v_mfma_f32_16x16x32_bf16 v[96:99], v[204:207], v[56:59], v[96:99]
    ds_read_b128 v[156:159], v6 offset:27648
    v_mfma_f32_16x16x32_bf16 v[100:103], v[208:211], v[56:59], v[100:103]
    ds_read_b128 v[160:163], v6 offset:28672
    v_mfma_f32_16x16x32_bf16 v[104:107], v[212:215], v[56:59], v[104:107]
    ds_read_b128 v[164:167], v6 offset:29696
    v_mfma_f32_16x16x32_bf16 v[108:111], v[216:219], v[56:59], v[108:111]
    buffer_load_dwordx4 v[80:83], v3, s[48:51], s66 offen sc1
    s_add_u32 s66, s66, 131072
    s_waitcnt vmcnt(5)
    s_waitcnt lgkmcnt(15)
    v_mfma_f32_16x16x32_bf16 v[92:95], v[220:223], v[60:63], v[92:95]
    ds_read_b128 v[168:171], v6 offset:30720
    v_mfma_f32_16x16x32_bf16 v[96:99], v[224:227], v[60:63], v[96:99]
    ds_read_b128 v[172:175], v6 offset:31744
    v_mfma_f32_16x16x32_bf16 v[100:103], v[228:231], v[60:63], v[100:103]
    ds_read_b128 v[176:179], v6 offset:32768
    v_mfma_f32_16x16x32_bf16 v[104:107], v[232:235], v[60:63], v[104:107]
    ds_read_b128 v[180:183], v6 offset:33792
    v_mfma_f32_16x16x32_bf16 v[108:111], v[236:239], v[60:63], v[108:111]
    buffer_load_dwordx4 v[84:87], v3, s[48:51], s66 offen sc1
    s_add_u32 s66, s66, 131072
    s_waitcnt vmcnt(5)
    s_waitcnt lgkmcnt(14)
    v_mfma_f32_16x16x32_bf16 v[92:95], v[240:243], v[64:67], v[92:95]
    ds_read_b128 v[184:187], v6 offset:34816
    v_mfma_f32_16x16x32_bf16 v[96:99], v[112:115], v[64:67], v[96:99]
    ds_read_b128 v[188:191], v6 offset:35840
    v_mfma_f32_16x16x32_bf16 v[100:103], v[116:119], v[64:67], v[100:103]
    ds_read_b128 v[192:195], v6 offset:36864
    v_mfma_f32_16x16x32_bf16 v[104:107], v[120:123], v[64:67], v[104:107]
    ds_read_b128 v[196:199], v6 offset:37888
    v_mfma_f32_16x16x32_bf16 v[108:111], v[124:127], v[64:67], v[108:111]
    buffer_load_dwordx4 v[88:91], v3, s[48:51], s66 offen sc1
    s_waitcnt vmcnt(5)
    s_waitcnt lgkmcnt(13)
    v_mfma_f32_16x16x32_bf16 v[92:95], v[128:131], v[68:71], v[92:95]
    ds_read_b128 v[200:203], v6 offset:38912
    v_mfma_f32_16x16x32_bf16 v[96:99], v[132:135], v[68:71], v[96:99]
    ds_read_b128 v[204:207], v6 offset:39936
    v_mfma_f32_16x16x32_bf16 v[100:103], v[136:139], v[68:71], v[100:103]
    ds_read_b128 v[208:211], v6 offset:40960
    v_mfma_f32_16x16x32_bf16 v[104:107], v[140:143], v[68:71], v[104:107]
    ds_read_b128 v[212:215], v6 offset:41984
    v_mfma_f32_16x16x32_bf16 v[108:111], v[144:147], v[68:71], v[108:111]
    s_waitcnt vmcnt(4)
    s_waitcnt lgkmcnt(12)
    v_mfma_f32_16x16x32_bf16 v[92:95], v[148:151], v[72:75], v[92:95]
    ds_read_b128 v[216:219], v6 offset:43008
    v_mfma_f32_16x16x32_bf16 v[96:99], v[152:155], v[72:75], v[96:99]
    ds_read_b128 v[220:223], v6 offset:44032
    v_mfma_f32_16x16x32_bf16 v[100:103], v[156:159], v[72:75], v[100:103]
    ds_read_b128 v[224:227], v6 offset:45056
    v_mfma_f32_16x16x32_bf16 v[104:107], v[160:163], v[72:75], v[104:107]
    ds_read_b128 v[228:231], v6 offset:46080
    v_mfma_f32_16x16x32_bf16 v[108:111], v[164:167], v[72:75], v[108:111]
    s_waitcnt vmcnt(3)
    s_waitcnt lgkmcnt(11)
    v_mfma_f32_16x16x32_bf16 v[92:95], v[168:171], v[76:79], v[92:95]
    ds_read_b128 v[232:235], v6 offset:47104
    v_mfma_f32_16x16x32_bf16 v[96:99], v[172:175], v[76:79], v[96:99]
    ds_read_b128 v[236:239], v6 offset:48128
    v_mfma_f32_16x16x32_bf16 v[100:103], v[176:179], v[76:79], v[100:103]
    ds_read_b128 v[240:243], v6 offset:49152
    v_mfma_f32_16x16x32_bf16 v[104:107], v[180:183], v[76:79], v[104:107]
    ds_read_b128 v[112:115], v6 offset:50176
    v_mfma_f32_16x16x32_bf16 v[108:111], v[184:187], v[76:79], v[108:111]
    s_waitcnt vmcnt(2)
    s_waitcnt lgkmcnt(10)
    v_mfma_f32_16x16x32_bf16 v[92:95], v[188:191], v[80:83], v[92:95]
    v_mfma_f32_16x16x32_bf16 v[96:99], v[192:195], v[80:83], v[96:99]
    v_mfma_f32_16x16x32_bf16 v[100:103], v[196:199], v[80:83], v[100:103]
    v_mfma_f32_16x16x32_bf16 v[104:107], v[200:203], v[80:83], v[104:107]
    v_mfma_f32_16x16x32_bf16 v[108:111], v[204:207], v[80:83], v[108:111]
    s_waitcnt vmcnt(1)
    s_waitcnt lgkmcnt(5)
    v_mfma_f32_16x16x32_bf16 v[92:95], v[208:211], v[84:87], v[92:95]
    v_mfma_f32_16x16x32_bf16 v[96:99], v[212:215], v[84:87], v[96:99]
    v_mfma_f32_16x16x32_bf16 v[100:103], v[216:219], v[84:87], v[100:103]
    v_mfma_f32_16x16x32_bf16 v[104:107], v[220:223], v[84:87], v[104:107]
    v_mfma_f32_16x16x32_bf16 v[108:111], v[224:227], v[84:87], v[108:111]
    s_waitcnt vmcnt(0)
    s_waitcnt lgkmcnt(0)
    v_mfma_f32_16x16x32_bf16 v[92:95], v[228:231], v[88:91], v[92:95]
    v_mfma_f32_16x16x32_bf16 v[96:99], v[232:235], v[88:91], v[96:99]
    v_mfma_f32_16x16x32_bf16 v[100:103], v[236:239], v[88:91], v[100:103]
    v_mfma_f32_16x16x32_bf16 v[104:107], v[240:243], v[88:91], v[104:107]
    v_mfma_f32_16x16x32_bf16 v[108:111], v[112:115], v[88:91], v[108:111]
    v_mul_u32_u24 v1, 2560, v9
    v_lshl_add_u32 v2, v10, 3, v1
    v_and_b32 v3, 1, v10
    v_lshl_add_u32 v1, v3, 5, v1
    v_lshrrev_b32 v3, 1, v10
    v_lshl_add_u32 v1, v3, 4, v1
    s_mul_i32 s66, s10, 160
    v_cvt_pk_bf16_f32 v12, v92, v93
    v_cvt_pk_bf16_f32 v13, v94, v95
    v_cvt_pk_bf16_f32 v14, v96, v97
    v_cvt_pk_bf16_f32 v15, v98, v99
    v_cvt_pk_bf16_f32 v16, v100, v101
    v_cvt_pk_bf16_f32 v17, v102, v103
    v_cvt_pk_bf16_f32 v18, v104, v105
    v_cvt_pk_bf16_f32 v19, v106, v107
    v_cvt_pk_bf16_f32 v20, v108, v109
    v_cvt_pk_bf16_f32 v21, v110, v111
    v_permlane16_swap_b32 v12, v14
    v_permlane16_swap_b32 v13, v15
    buffer_store_dwordx4 v[12:15], v1, s[56:59], s66 offen offset:0 nt
    v_permlane16_swap_b32 v16, v18
    v_permlane16_swap_b32 v17, v19
    buffer_store_dwordx4 v[16:19], v1, s[56:59], s66 offen offset:64 nt
    buffer_store_dwordx2 v[20:21], v2, s[56:59], s66 offen offset:128 nt
    s_endpgm
.La_idp:
    s_mov_b32 s74, 16384
.Lpoll_48:
    buffer_load_dwordx4 v[172:175], v201, s[48:51], 0 offen sc1
    s_waitcnt vmcnt(0)
    v_cmp_ne_u64 vcc, s[64:65], v[172:173]
    s_nop 0
    s_and_b64 exec, exec, vcc
    s_cbranch_scc0 .Lpolld_49
    s_sleep 2
    s_sub_u32 s74, s74, 1
    s_cbranch_scc0 .Lpoll_48
.Lpolld_49:
    s_mov_b64 exec, -1
    s_branch .La_ids
.La_slow:
    v_mov_b32 v168, v10
    v_mov_b32 v169, v10
    s_lshl_b32 s66, s3, 1
    s_cmp_eq_u32 s4, 0
    s_cselect_b32 s66, s66, 8
    s_cmp_lt_u32 s66, 8
    s_cbranch_scc1 .Lskip_50
    ds_read_b128 v[140:143], v207 offset:0
    ds_read_b64 v[144:145], v208 offset:0
    s_waitcnt lgkmcnt(0)
    v_mfma_f32_32x32x16_bf16 v[16:31], v[140:143], v[128:131], v[112:127]
    v_mfma_f32_32x32x8_bf16 v[16:31], v[144:145], v[132:133], v[16:31]
    s_nop 15
    v_max3_f32 v168, v168, v16, v17
    v_max3_f32 v168, v168, v18, v19
    v_max3_f32 v168, v168, v20, v21
    v_max3_f32 v168, v168, v22, v23
    v_max3_f32 v168, v168, v24, v25
    v_max3_f32 v168, v168, v26, v27
    v_max3_f32 v168, v168, v28, v29
    v_max3_f32 v168, v168, v30, v31
.Lskip_50:
    s_cmp_lt_u32 s66, 7
    s_cbranch_scc1 .Lskip_51
    ds_read_b128 v[146:149], v207 offset:512
    ds_read_b64 v[150:151], v208 offset:512
    s_waitcnt lgkmcnt(0)
    v_mfma_f32_32x32x16_bf16 v[32:47], v[146:149], v[128:131], 0
    v_mfma_f32_32x32x8_bf16 v[32:47], v[150:151], v[132:133], v[32:47]
    s_nop 15
    v_max3_f32 v168, v168, v32, v33
    v_max3_f32 v168, v168, v34, v35
    v_max3_f32 v168, v168, v36, v37
    v_max3_f32 v168, v168, v38, v39
    v_max3_f32 v168, v168, v40, v41
    v_max3_f32 v168, v168, v42, v43
    v_max3_f32 v168, v168, v44, v45
    v_max3_f32 v168, v168, v46, v47
.Lskip_51:
    s_cmp_lt_u32 s66, 7
    s_cbranch_scc1 .Lskip_52
    ds_read_b128 v[146:149], v207 offset:512
    ds_read_b64 v[150:151], v208 offset:512
    s_waitcnt lgkmcnt(0)
    v_mfma_f32_32x32x16_bf16 v[16:31], v[146:149], v[134:137], v[112:127]
    v_mfma_f32_32x32x8_bf16 v[16:31], v[150:151], v[138:139], v[16:31]
    s_nop 15
    v_max3_f32 v169, v169, v16, v17
    v_max3_f32 v169, v169, v18, v19
    v_max3_f32 v169, v169, v20, v21
    v_max3_f32 v169, v169, v22, v23
    v_max3_f32 v169, v169, v24, v25
    v_max3_f32 v169, v169, v26, v27
    v_max3_f32 v169, v169, v28, v29
    v_max3_f32 v169, v169, v30, v31
.Lskip_52:
    s_cmp_lt_u32 s66, 6
    s_cbranch_scc1 .Lskip_53
    ds_read_b128 v[140:143], v207 offset:1024
    ds_read_b64 v[144:145], v208 offset:1024
    s_waitcnt lgkmcnt(0)
    v_mfma_f32_32x32x16_bf16 v[32:47], v[140:143], v[128:131], 0
    v_mfma_f32_32x32x8_bf16 v[32:47], v[144:145], v[132:133], v[32:47]
    s_nop 15
    v_max3_f32 v168, v168, v32, v33
    v_max3_f32 v168, v168, v34, v35
    v_max3_f32 v168, v168, v36, v37
    v_max3_f32 v168, v168, v38, v39
    v_max3_f32 v168, v168, v40, v41
    v_max3_f32 v168, v168, v42, v43
    v_max3_f32 v168, v168, v44, v45
    v_max3_f32 v168, v168, v46, v47
.Lskip_53:
    s_cmp_lt_u32 s66, 6
    s_cbranch_scc1 .Lskip_54
    ds_read_b128 v[140:143], v207 offset:1024
    ds_read_b64 v[144:145], v208 offset:1024
    s_waitcnt lgkmcnt(0)
    v_mfma_f32_32x32x16_bf16 v[16:31], v[140:143], v[134:137], 0
    v_mfma_f32_32x32x8_bf16 v[16:31], v[144:145], v[138:139], v[16:31]
    s_nop 15
    v_max3_f32 v169, v169, v16, v17
    v_max3_f32 v169, v169, v18, v19
    v_max3_f32 v169, v169, v20, v21
    v_max3_f32 v169, v169, v22, v23
    v_max3_f32 v169, v169, v24, v25
    v_max3_f32 v169, v169, v26, v27
    v_max3_f32 v169, v169, v28, v29
    v_max3_f32 v169, v169, v30, v31
.Lskip_54:
    s_cmp_lt_u32 s66, 5
    s_cbranch_scc1 .Lskip_55
    ds_read_b128 v[146:149], v207 offset:1536
    ds_read_b64 v[150:151], v208 offset:1536
    s_waitcnt lgkmcnt(0)
    v_mfma_f32_32x32x16_bf16 v[32:47], v[146:149], v[128:131], 0
    v_mfma_f32_32x32x8_bf16 v[32:47], v[150:151], v[132:133], v[32:47]
    s_nop 15
    v_max3_f32 v168, v168, v32, v33
    v_max3_f32 v168, v168, v34, v35
    v_max3_f32 v168, v168, v36, v37
    v_max3_f32 v168, v168, v38, v39
    v_max3_f32 v168, v168, v40, v41
    v_max3_f32 v168, v168, v42, v43
    v_max3_f32 v168, v168, v44, v45
    v_max3_f32 v168, v168, v46, v47
.Lskip_55:
    s_cmp_lt_u32 s66, 5
    s_cbranch_scc1 .Lskip_56
    ds_read_b128 v[146:149], v207 offset:1536
    ds_read_b64 v[150:151], v208 offset:1536
    s_waitcnt lgkmcnt(0)
    v_mfma_f32_32x32x16_bf16 v[16:31], v[146:149], v[134:137], 0
    v_mfma_f32_32x32x8_bf16 v[16:31], v[150:151], v[138:139], v[16:31]
    s_nop 15
    v_max3_f32 v169, v169, v16, v17
    v_max3_f32 v169, v169, v18, v19
    v_max3_f32 v169, v169, v20, v21
    v_max3_f32 v169, v169, v22, v23
    v_max3_f32 v169, v169, v24, v25
    v_max3_f32 v169, v169, v26, v27
    v_max3_f32 v169, v169, v28, v29
    v_max3_f32 v169, v169, v30, v31
.Lskip_56:
    s_cmp_lt_u32 s66, 4
    s_cbranch_scc1 .Lskip_57
    ds_read_b128 v[140:143], v207 offset:2048
    ds_read_b64 v[144:145], v208 offset:2048
    s_waitcnt lgkmcnt(0)
    v_mfma_f32_32x32x16_bf16 v[32:47], v[140:143], v[128:131], 0
    v_mfma_f32_32x32x8_bf16 v[32:47], v[144:145], v[132:133], v[32:47]
    s_nop 15
    v_max3_f32 v168, v168, v32, v33
    v_max3_f32 v168, v168, v34, v35
    v_max3_f32 v168, v168, v36, v37
    v_max3_f32 v168, v168, v38, v39
    v_max3_f32 v168, v168, v40, v41
    v_max3_f32 v168, v168, v42, v43
    v_max3_f32 v168, v168, v44, v45
    v_max3_f32 v168, v168, v46, v47
.Lskip_57:
    s_cmp_lt_u32 s66, 4
    s_cbranch_scc1 .Lskip_58
    ds_read_b128 v[140:143], v207 offset:2048
    ds_read_b64 v[144:145], v208 offset:2048
    s_waitcnt lgkmcnt(0)
    v_mfma_f32_32x32x16_bf16 v[16:31], v[140:143], v[134:137], 0
    v_mfma_f32_32x32x8_bf16 v[16:31], v[144:145], v[138:139], v[16:31]
    s_nop 15
    v_max3_f32 v169, v169, v16, v17
    v_max3_f32 v169, v169, v18, v19
    v_max3_f32 v169, v169, v20, v21
    v_max3_f32 v169, v169, v22, v23
    v_max3_f32 v169, v169, v24, v25
    v_max3_f32 v169, v169, v26, v27
    v_max3_f32 v169, v169, v28, v29
    v_max3_f32 v169, v169, v30, v31
.Lskip_58:
    s_cmp_lt_u32 s66, 3
    s_cbranch_scc1 .Lskip_59
    ds_read_b128 v[146:149], v207 offset:2560
    ds_read_b64 v[150:151], v208 offset:2560
    s_waitcnt lgkmcnt(0)
    v_mfma_f32_32x32x16_bf16 v[32:47], v[146:149], v[128:131], 0
    v_mfma_f32_32x32x8_bf16 v[32:47], v[150:151], v[132:133], v[32:47]
    s_nop 15
    v_max3_f32 v168, v168, v32, v33
    v_max3_f32 v168, v168, v34, v35
    v_max3_f32 v168, v168, v36, v37
    v_max3_f32 v168, v168, v38, v39
    v_max3_f32 v168, v168, v40, v41
    v_max3_f32 v168, v168, v42, v43
    v_max3_f32 v168, v168, v44, v45
    v_max3_f32 v168, v168, v46, v47
.Lskip_59:
    s_cmp_lt_u32 s66, 3
    s_cbranch_scc1 .Lskip_60
    ds_read_b128 v[146:149], v207 offset:2560
    ds_read_b64 v[150:151], v208 offset:2560
    s_waitcnt lgkmcnt(0)
    v_mfma_f32_32x32x16_bf16 v[16:31], v[146:149], v[134:137], 0
    v_mfma_f32_32x32x8_bf16 v[16:31], v[150:151], v[138:139], v[16:31]
    s_nop 15
    v_max3_f32 v169, v169, v16, v17
    v_max3_f32 v169, v169, v18, v19
    v_max3_f32 v169, v169, v20, v21
    v_max3_f32 v169, v169, v22, v23
    v_max3_f32 v169, v169, v24, v25
    v_max3_f32 v169, v169, v26, v27
    v_max3_f32 v169, v169, v28, v29
    v_max3_f32 v169, v169, v30, v31
.Lskip_60:
    s_cmp_lt_u32 s66, 2
    s_cbranch_scc1 .Lskip_61
    ds_read_b128 v[140:143], v207 offset:3072
    ds_read_b64 v[144:145], v208 offset:3072
    s_waitcnt lgkmcnt(0)
    v_mfma_f32_32x32x16_bf16 v[32:47], v[140:143], v[128:131], 0
    v_mfma_f32_32x32x8_bf16 v[32:47], v[144:145], v[132:133], v[32:47]
    s_nop 15
    v_max3_f32 v168, v168, v32, v33
    v_max3_f32 v168, v168, v34, v35
    v_max3_f32 v168, v168, v36, v37
    v_max3_f32 v168, v168, v38, v39
    v_max3_f32 v168, v168, v40, v41
    v_max3_f32 v168, v168, v42, v43
    v_max3_f32 v168, v168, v44, v45
    v_max3_f32 v168, v168, v46, v47
.Lskip_61:
    s_cmp_lt_u32 s66, 2
    s_cbranch_scc1 .Lskip_62
    ds_read_b128 v[140:143], v207 offset:3072
    ds_read_b64 v[144:145], v208 offset:3072
    s_waitcnt lgkmcnt(0)
    v_mfma_f32_32x32x16_bf16 v[16:31], v[140:143], v[134:137], 0
    v_mfma_f32_32x32x8_bf16 v[16:31], v[144:145], v[138:139], v[16:31]
    s_nop 15
    v_max3_f32 v169, v169, v16, v17
    v_max3_f32 v169, v169, v18, v19
    v_max3_f32 v169, v169, v20, v21
    v_max3_f32 v169, v169, v22, v23
    v_max3_f32 v169, v169, v24, v25
    v_max3_f32 v169, v169, v26, v27
    v_max3_f32 v169, v169, v28, v29
    v_max3_f32 v169, v169, v30, v31
.Lskip_62:
    s_cmp_lt_u32 s66, 1
    s_cbranch_scc1 .Lskip_63
    ds_read_b128 v[146:149], v207 offset:3584
    ds_read_b64 v[150:151], v208 offset:3584
    s_waitcnt lgkmcnt(0)
    v_mfma_f32_32x32x16_bf16 v[32:47], v[146:149], v[128:131], 0
    v_mfma_f32_32x32x8_bf16 v[32:47], v[150:151], v[132:133], v[32:47]
    s_nop 15
    v_max3_f32 v168, v168, v32, v33
    v_max3_f32 v168, v168, v34, v35
    v_max3_f32 v168, v168, v36, v37
    v_max3_f32 v168, v168, v38, v39
    v_max3_f32 v168, v168, v40, v41
    v_max3_f32 v168, v168, v42, v43
    v_max3_f32 v168, v168, v44, v45
    v_max3_f32 v168, v168, v46, v47
.Lskip_63:
    s_cmp_lt_u32 s66, 1
    s_cbranch_scc1 .Lskip_64
    ds_read_b128 v[146:149], v207 offset:3584
    ds_read_b64 v[150:151], v208 offset:3584
    s_waitcnt lgkmcnt(0)
    v_mfma_f32_32x32x16_bf16 v[16:31], v[146:149], v[134:137], 0
    v_mfma_f32_32x32x8_bf16 v[16:31], v[150:151], v[138:139], v[16:31]
    s_nop 15
    v_max3_f32 v169, v169, v16, v17
    v_max3_f32 v169, v169, v18, v19
    v_max3_f32 v169, v169, v20, v21
    v_max3_f32 v169, v169, v22, v23
    v_max3_f32 v169, v169, v24, v25
    v_max3_f32 v169, v169, v26, v27
    v_max3_f32 v169, v169, v28, v29
    v_max3_f32 v169, v169, v30, v31
.Lskip_64:
    ds_read_b128 v[140:143], v207 offset:4096
    ds_read_b64 v[144:145], v208 offset:4096
    s_waitcnt lgkmcnt(0)
    v_mfma_f32_32x32x16_bf16 v[32:47], v[140:143], v[128:131], v[96:111]
    v_mfma_f32_32x32x8_bf16 v[32:47], v[144:145], v[132:133], v[32:47]
    s_nop 15
    v_max3_f32 v168, v168, v32, v33
    v_max3_f32 v168, v168, v34, v35
    v_max3_f32 v168, v168, v36, v37
    v_max3_f32 v168, v168, v38, v39
    v_max3_f32 v168, v168, v40, v41
    v_max3_f32 v168, v168, v42, v43
    v_max3_f32 v168, v168, v44, v45
    v_max3_f32 v168, v168, v46, v47
.Lskip_65:
    ds_read_b128 v[140:143], v207 offset:4096
    ds_read_b64 v[144:145], v208 offset:4096
    s_waitcnt lgkmcnt(0)
    v_mfma_f32_32x32x16_bf16 v[16:31], v[140:143], v[134:137], 0
    v_mfma_f32_32x32x8_bf16 v[16:31], v[144:145], v[138:139], v[16:31]
    s_nop 15
    v_max3_f32 v169, v169, v16, v17
    v_max3_f32 v169, v169, v18, v19
    v_max3_f32 v169, v169, v20, v21
    v_max3_f32 v169, v169, v22, v23
    v_max3_f32 v169, v169, v24, v25
    v_max3_f32 v169, v169, v26, v27
    v_max3_f32 v169, v169, v28, v29
    v_max3_f32 v169, v169, v30, v31
.Lskip_66:
    ds_read_b128 v[146:149], v207 offset:4608
    ds_read_b64 v[150:151], v208 offset:4608
    s_waitcnt lgkmcnt(0)
    v_mfma_f32_32x32x16_bf16 v[32:47], v[146:149], v[134:137], v[96:111]
    v_mfma_f32_32x32x8_bf16 v[32:47], v[150:151], v[138:139], v[32:47]
    s_nop 15
    v_max3_f32 v169, v169, v32, v33
    v_max3_f32 v169, v169, v34, v35
    v_max3_f32 v169, v169, v36, v37
    v_max3_f32 v169, v169, v38, v39
    v_max3_f32 v169, v169, v40, v41
    v_max3_f32 v169, v169, v42, v43
    v_max3_f32 v169, v169, v44, v45
    v_max3_f32 v169, v169, v46, v47
.Lskip_67:
    v_mov_b32 v170, v168
    v_mov_b32 v171, v169
    s_nop 0
    v_permlane32_swap_b32 v168, v170
    v_permlane32_swap_b32 v169, v171
    v_max_f32 v168, v168, v170
    v_max_f32 v169, v169, v171
    ds_read_b128 v[140:143], v207 offset:0
    ds_read_b64 v[144:145], v208 offset:0
    ds_read_b64_tr_b16 v[152:153], v209 offset:0
    ds_read_b64_tr_b16 v[154:155], v209 offset:128
    ds_read_b64_tr_b16 v[156:157], v209 offset:256
    ds_read_b64_tr_b16 v[158:159], v209 offset:384
    s_waitcnt lgkmcnt(4)
    v_mfma_f32_32x32x16_bf16 v[16:31], v[140:143], v[128:131], v[112:127]
    v_mfma_f32_32x32x8_bf16 v[16:31], v[144:145], v[132:133], v[16:31]
    s_nop 15
    v_sub_f32 v16, v16, v168
    v_min_f32 v16, 0, v16
    v_exp_f32 v16, v16
    v_sub_f32 v17, v17, v168
    v_min_f32 v17, 0, v17
    v_exp_f32 v17, v17
    v_sub_f32 v18, v18, v168
    v_min_f32 v18, 0, v18
    v_exp_f32 v18, v18
    v_sub_f32 v19, v19, v168
    v_min_f32 v19, 0, v19
    v_exp_f32 v19, v19
    v_sub_f32 v20, v20, v168
    v_min_f32 v20, 0, v20
    v_exp_f32 v20, v20
    v_sub_f32 v21, v21, v168
    v_min_f32 v21, 0, v21
    v_exp_f32 v21, v21
    v_sub_f32 v22, v22, v168
    v_min_f32 v22, 0, v22
    v_exp_f32 v22, v22
    v_sub_f32 v23, v23, v168
    v_min_f32 v23, 0, v23
    v_exp_f32 v23, v23
    v_sub_f32 v24, v24, v168
    v_min_f32 v24, 0, v24
    v_exp_f32 v24, v24
    v_sub_f32 v25, v25, v168
    v_min_f32 v25, 0, v25
    v_exp_f32 v25, v25
    v_sub_f32 v26, v26, v168
    v_min_f32 v26, 0, v26
    v_exp_f32 v26, v26
    v_sub_f32 v27, v27, v168
    v_min_f32 v27, 0, v27
    v_exp_f32 v27, v27
    v_sub_f32 v28, v28, v168
    v_min_f32 v28, 0, v28
    v_exp_f32 v28, v28
    v_sub_f32 v29, v29, v168
    v_min_f32 v29, 0, v29
    v_exp_f32 v29, v29
    v_sub_f32 v30, v30, v168
    v_min_f32 v30, 0, v30
    v_exp_f32 v30, v30
    v_sub_f32 v31, v31, v168
    v_min_f32 v31, 0, v31
    v_exp_f32 v31, v31
    v_cvt_pk_bf16_f32 v48, v16, v17
    v_cvt_pk_bf16_f32 v49, v18, v19
    v_cvt_pk_bf16_f32 v50, v20, v21
    v_cvt_pk_bf16_f32 v51, v22, v23
    v_cvt_pk_bf16_f32 v52, v24, v25
    v_cvt_pk_bf16_f32 v53, v26, v27
    v_cvt_pk_bf16_f32 v54, v28, v29
    v_cvt_pk_bf16_f32 v55, v30, v31
    s_waitcnt lgkmcnt(0)
    v_mfma_f32_32x32x16_bf16 v[64:79], v[152:155], v[48:51], 0
    v_mfma_f32_32x32x16_bf16 v[64:79], v[156:159], v[52:55], v[64:79]
    ds_read_b128 v[146:149], v207 offset:512
    ds_read_b64 v[150:151], v208 offset:512
    ds_read_b64_tr_b16 v[160:161], v209 offset:512
    ds_read_b64_tr_b16 v[162:163], v209 offset:640
    ds_read_b64_tr_b16 v[164:165], v209 offset:768
    ds_read_b64_tr_b16 v[166:167], v209 offset:896
    s_waitcnt lgkmcnt(4)
    v_mfma_f32_32x32x16_bf16 v[32:47], v[146:149], v[128:131], 0
    v_mfma_f32_32x32x8_bf16 v[32:47], v[150:151], v[132:133], v[32:47]
    s_nop 15
    v_sub_f32 v32, v32, v168
    v_min_f32 v32, 0, v32
    v_exp_f32 v32, v32
    v_sub_f32 v33, v33, v168
    v_min_f32 v33, 0, v33
    v_exp_f32 v33, v33
    v_sub_f32 v34, v34, v168
    v_min_f32 v34, 0, v34
    v_exp_f32 v34, v34
    v_sub_f32 v35, v35, v168
    v_min_f32 v35, 0, v35
    v_exp_f32 v35, v35
    v_sub_f32 v36, v36, v168
    v_min_f32 v36, 0, v36
    v_exp_f32 v36, v36
    v_sub_f32 v37, v37, v168
    v_min_f32 v37, 0, v37
    v_exp_f32 v37, v37
    v_sub_f32 v38, v38, v168
    v_min_f32 v38, 0, v38
    v_exp_f32 v38, v38
    v_sub_f32 v39, v39, v168
    v_min_f32 v39, 0, v39
    v_exp_f32 v39, v39
    v_sub_f32 v40, v40, v168
    v_min_f32 v40, 0, v40
    v_exp_f32 v40, v40
    v_sub_f32 v41, v41, v168
    v_min_f32 v41, 0, v41
    v_exp_f32 v41, v41
    v_sub_f32 v42, v42, v168
    v_min_f32 v42, 0, v42
    v_exp_f32 v42, v42
    v_sub_f32 v43, v43, v168
    v_min_f32 v43, 0, v43
    v_exp_f32 v43, v43
    v_sub_f32 v44, v44, v168
    v_min_f32 v44, 0, v44
    v_exp_f32 v44, v44
    v_sub_f32 v45, v45, v168
    v_min_f32 v45, 0, v45
    v_exp_f32 v45, v45
    v_sub_f32 v46, v46, v168
    v_min_f32 v46, 0, v46
    v_exp_f32 v46, v46
    v_sub_f32 v47, v47, v168
    v_min_f32 v47, 0, v47
    v_exp_f32 v47, v47
    v_cvt_pk_bf16_f32 v56, v32, v33
    v_cvt_pk_bf16_f32 v57, v34, v35
    v_cvt_pk_bf16_f32 v58, v36, v37
    v_cvt_pk_bf16_f32 v59, v38, v39
    v_cvt_pk_bf16_f32 v60, v40, v41
    v_cvt_pk_bf16_f32 v61, v42, v43
    v_cvt_pk_bf16_f32 v62, v44, v45
    v_cvt_pk_bf16_f32 v63, v46, v47
    s_waitcnt lgkmcnt(0)
    v_mfma_f32_32x32x16_bf16 v[64:79], v[160:163], v[56:59], v[64:79]
    v_mfma_f32_32x32x16_bf16 v[64:79], v[164:167], v[60:63], v[64:79]
    ds_read_b128 v[146:149], v207 offset:512
    ds_read_b64 v[150:151], v208 offset:512
    ds_read_b64_tr_b16 v[160:161], v209 offset:512
    ds_read_b64_tr_b16 v[162:163], v209 offset:640
    ds_read_b64_tr_b16 v[164:165], v209 offset:768
    ds_read_b64_tr_b16 v[166:167], v209 offset:896
    s_waitcnt lgkmcnt(4)
    v_mfma_f32_32x32x16_bf16 v[16:31], v[146:149], v[134:137], v[112:127]
    v_mfma_f32_32x32x8_bf16 v[16:31], v[150:151], v[138:139], v[16:31]
    s_nop 15
    v_sub_f32 v16, v16, v169
    v_min_f32 v16, 0, v16
    v_exp_f32 v16, v16
    v_sub_f32 v17, v17, v169
    v_min_f32 v17, 0, v17
    v_exp_f32 v17, v17
    v_sub_f32 v18, v18, v169
    v_min_f32 v18, 0, v18
    v_exp_f32 v18, v18
    v_sub_f32 v19, v19, v169
    v_min_f32 v19, 0, v19
    v_exp_f32 v19, v19
    v_sub_f32 v20, v20, v169
    v_min_f32 v20, 0, v20
    v_exp_f32 v20, v20
    v_sub_f32 v21, v21, v169
    v_min_f32 v21, 0, v21
    v_exp_f32 v21, v21
    v_sub_f32 v22, v22, v169
    v_min_f32 v22, 0, v22
    v_exp_f32 v22, v22
    v_sub_f32 v23, v23, v169
    v_min_f32 v23, 0, v23
    v_exp_f32 v23, v23
    v_sub_f32 v24, v24, v169
    v_min_f32 v24, 0, v24
    v_exp_f32 v24, v24
    v_sub_f32 v25, v25, v169
    v_min_f32 v25, 0, v25
    v_exp_f32 v25, v25
    v_sub_f32 v26, v26, v169
    v_min_f32 v26, 0, v26
    v_exp_f32 v26, v26
    v_sub_f32 v27, v27, v169
    v_min_f32 v27, 0, v27
    v_exp_f32 v27, v27
    v_sub_f32 v28, v28, v169
    v_min_f32 v28, 0, v28
    v_exp_f32 v28, v28
    v_sub_f32 v29, v29, v169
    v_min_f32 v29, 0, v29
    v_exp_f32 v29, v29
    v_sub_f32 v30, v30, v169
    v_min_f32 v30, 0, v30
    v_exp_f32 v30, v30
    v_sub_f32 v31, v31, v169
    v_min_f32 v31, 0, v31
    v_exp_f32 v31, v31
    v_cvt_pk_bf16_f32 v48, v16, v17
    v_cvt_pk_bf16_f32 v49, v18, v19
    v_cvt_pk_bf16_f32 v50, v20, v21
    v_cvt_pk_bf16_f32 v51, v22, v23
    v_cvt_pk_bf16_f32 v52, v24, v25
    v_cvt_pk_bf16_f32 v53, v26, v27
    v_cvt_pk_bf16_f32 v54, v28, v29
    v_cvt_pk_bf16_f32 v55, v30, v31
    s_waitcnt lgkmcnt(0)
    v_mfma_f32_32x32x16_bf16 v[80:95], v[160:163], v[48:51], 0
    v_mfma_f32_32x32x16_bf16 v[80:95], v[164:167], v[52:55], v[80:95]
    ds_read_b128 v[140:143], v207 offset:1024
    ds_read_b64 v[144:145], v208 offset:1024
    ds_read_b64_tr_b16 v[152:153], v209 offset:1024
    ds_read_b64_tr_b16 v[154:155], v209 offset:1152
    ds_read_b64_tr_b16 v[156:157], v209 offset:1280
    ds_read_b64_tr_b16 v[158:159], v209 offset:1408
    s_waitcnt lgkmcnt(4)
    v_mfma_f32_32x32x16_bf16 v[32:47], v[140:143], v[128:131], 0
    v_mfma_f32_32x32x8_bf16 v[32:47], v[144:145], v[132:133], v[32:47]
    s_nop 15
    v_sub_f32 v32, v32, v168
    v_min_f32 v32, 0, v32
    v_exp_f32 v32, v32
    v_sub_f32 v33, v33, v168
    v_min_f32 v33, 0, v33
    v_exp_f32 v33, v33
    v_sub_f32 v34, v34, v168
    v_min_f32 v34, 0, v34
    v_exp_f32 v34, v34
    v_sub_f32 v35, v35, v168
    v_min_f32 v35, 0, v35
    v_exp_f32 v35, v35
    v_sub_f32 v36, v36, v168
    v_min_f32 v36, 0, v36
    v_exp_f32 v36, v36
    v_sub_f32 v37, v37, v168
    v_min_f32 v37, 0, v37
    v_exp_f32 v37, v37
    v_sub_f32 v38, v38, v168
    v_min_f32 v38, 0, v38
    v_exp_f32 v38, v38
    v_sub_f32 v39, v39, v168
    v_min_f32 v39, 0, v39
    v_exp_f32 v39, v39
    v_sub_f32 v40, v40, v168
    v_min_f32 v40, 0, v40
    v_exp_f32 v40, v40
    v_sub_f32 v41, v41, v168
    v_min_f32 v41, 0, v41
    v_exp_f32 v41, v41
    v_sub_f32 v42, v42, v168
    v_min_f32 v42, 0, v42
    v_exp_f32 v42, v42
    v_sub_f32 v43, v43, v168
    v_min_f32 v43, 0, v43
    v_exp_f32 v43, v43
    v_sub_f32 v44, v44, v168
    v_min_f32 v44, 0, v44
    v_exp_f32 v44, v44
    v_sub_f32 v45, v45, v168
    v_min_f32 v45, 0, v45
    v_exp_f32 v45, v45
    v_sub_f32 v46, v46, v168
    v_min_f32 v46, 0, v46
    v_exp_f32 v46, v46
    v_sub_f32 v47, v47, v168
    v_min_f32 v47, 0, v47
    v_exp_f32 v47, v47
    v_cvt_pk_bf16_f32 v56, v32, v33
    v_cvt_pk_bf16_f32 v57, v34, v35
    v_cvt_pk_bf16_f32 v58, v36, v37
    v_cvt_pk_bf16_f32 v59, v38, v39
    v_cvt_pk_bf16_f32 v60, v40, v41
    v_cvt_pk_bf16_f32 v61, v42, v43
    v_cvt_pk_bf16_f32 v62, v44, v45
    v_cvt_pk_bf16_f32 v63, v46, v47
    s_waitcnt lgkmcnt(0)
    v_mfma_f32_32x32x16_bf16 v[64:79], v[152:155], v[56:59], v[64:79]
    v_mfma_f32_32x32x16_bf16 v[64:79], v[156:159], v[60:63], v[64:79]
    ds_read_b128 v[140:143], v207 offset:1024
    ds_read_b64 v[144:145], v208 offset:1024
    ds_read_b64_tr_b16 v[152:153], v209 offset:1024
    ds_read_b64_tr_b16 v[154:155], v209 offset:1152
    ds_read_b64_tr_b16 v[156:157], v209 offset:1280
    ds_read_b64_tr_b16 v[158:159], v209 offset:1408
    s_waitcnt lgkmcnt(4)
    v_mfma_f32_32x32x16_bf16 v[16:31], v[140:143], v[134:137], 0
    v_mfma_f32_32x32x8_bf16 v[16:31], v[144:145], v[138:139], v[16:31]
    s_nop 15
    v_sub_f32 v16, v16, v169
    v_min_f32 v16, 0, v16
    v_exp_f32 v16, v16
    v_sub_f32 v17, v17, v169
    v_min_f32 v17, 0, v17
    v_exp_f32 v17, v17
    v_sub_f32 v18, v18, v169
    v_min_f32 v18, 0, v18
    v_exp_f32 v18, v18
    v_sub_f32 v19, v19, v169
    v_min_f32 v19, 0, v19
    v_exp_f32 v19, v19
    v_sub_f32 v20, v20, v169
    v_min_f32 v20, 0, v20
    v_exp_f32 v20, v20
    v_sub_f32 v21, v21, v169
    v_min_f32 v21, 0, v21
    v_exp_f32 v21, v21
    v_sub_f32 v22, v22, v169
    v_min_f32 v22, 0, v22
    v_exp_f32 v22, v22
    v_sub_f32 v23, v23, v169
    v_min_f32 v23, 0, v23
    v_exp_f32 v23, v23
    v_sub_f32 v24, v24, v169
    v_min_f32 v24, 0, v24
    v_exp_f32 v24, v24
    v_sub_f32 v25, v25, v169
    v_min_f32 v25, 0, v25
    v_exp_f32 v25, v25
    v_sub_f32 v26, v26, v169
    v_min_f32 v26, 0, v26
    v_exp_f32 v26, v26
    v_sub_f32 v27, v27, v169
    v_min_f32 v27, 0, v27
    v_exp_f32 v27, v27
    v_sub_f32 v28, v28, v169
    v_min_f32 v28, 0, v28
    v_exp_f32 v28, v28
    v_sub_f32 v29, v29, v169
    v_min_f32 v29, 0, v29
    v_exp_f32 v29, v29
    v_sub_f32 v30, v30, v169
    v_min_f32 v30, 0, v30
    v_exp_f32 v30, v30
    v_sub_f32 v31, v31, v169
    v_min_f32 v31, 0, v31
    v_exp_f32 v31, v31
    v_cvt_pk_bf16_f32 v48, v16, v17
    v_cvt_pk_bf16_f32 v49, v18, v19
    v_cvt_pk_bf16_f32 v50, v20, v21
    v_cvt_pk_bf16_f32 v51, v22, v23
    v_cvt_pk_bf16_f32 v52, v24, v25
    v_cvt_pk_bf16_f32 v53, v26, v27
    v_cvt_pk_bf16_f32 v54, v28, v29
    v_cvt_pk_bf16_f32 v55, v30, v31
    s_waitcnt lgkmcnt(0)
    v_mfma_f32_32x32x16_bf16 v[80:95], v[152:155], v[48:51], v[80:95]
    v_mfma_f32_32x32x16_bf16 v[80:95], v[156:159], v[52:55], v[80:95]
    ds_read_b128 v[146:149], v207 offset:1536
    ds_read_b64 v[150:151], v208 offset:1536
    ds_read_b64_tr_b16 v[160:161], v209 offset:1536
    ds_read_b64_tr_b16 v[162:163], v209 offset:1664
    ds_read_b64_tr_b16 v[164:165], v209 offset:1792
    ds_read_b64_tr_b16 v[166:167], v209 offset:1920
    s_waitcnt lgkmcnt(4)
    v_mfma_f32_32x32x16_bf16 v[32:47], v[146:149], v[128:131], 0
    v_mfma_f32_32x32x8_bf16 v[32:47], v[150:151], v[132:133], v[32:47]
    s_nop 15
    v_sub_f32 v32, v32, v168
    v_min_f32 v32, 0, v32
    v_exp_f32 v32, v32
    v_sub_f32 v33, v33, v168
    v_min_f32 v33, 0, v33
    v_exp_f32 v33, v33
    v_sub_f32 v34, v34, v168
    v_min_f32 v34, 0, v34
    v_exp_f32 v34, v34
    v_sub_f32 v35, v35, v168
    v_min_f32 v35, 0, v35
    v_exp_f32 v35, v35
    v_sub_f32 v36, v36, v168
    v_min_f32 v36, 0, v36
    v_exp_f32 v36, v36
    v_sub_f32 v37, v37, v168
    v_min_f32 v37, 0, v37
    v_exp_f32 v37, v37
    v_sub_f32 v38, v38, v168
    v_min_f32 v38, 0, v38
    v_exp_f32 v38, v38
    v_sub_f32 v39, v39, v168
    v_min_f32 v39, 0, v39
    v_exp_f32 v39, v39
    v_sub_f32 v40, v40, v168
    v_min_f32 v40, 0, v40
    v_exp_f32 v40, v40
    v_sub_f32 v41, v41, v168
    v_min_f32 v41, 0, v41
    v_exp_f32 v41, v41
    v_sub_f32 v42, v42, v168
    v_min_f32 v42, 0, v42
    v_exp_f32 v42, v42
    v_sub_f32 v43, v43, v168
    v_min_f32 v43, 0, v43
    v_exp_f32 v43, v43
    v_sub_f32 v44, v44, v168
    v_min_f32 v44, 0, v44
    v_exp_f32 v44, v44
    v_sub_f32 v45, v45, v168
    v_min_f32 v45, 0, v45
    v_exp_f32 v45, v45
    v_sub_f32 v46, v46, v168
    v_min_f32 v46, 0, v46
    v_exp_f32 v46, v46
    v_sub_f32 v47, v47, v168
    v_min_f32 v47, 0, v47
    v_exp_f32 v47, v47
    v_cvt_pk_bf16_f32 v56, v32, v33
    v_cvt_pk_bf16_f32 v57, v34, v35
    v_cvt_pk_bf16_f32 v58, v36, v37
    v_cvt_pk_bf16_f32 v59, v38, v39
    v_cvt_pk_bf16_f32 v60, v40, v41
    v_cvt_pk_bf16_f32 v61, v42, v43
    v_cvt_pk_bf16_f32 v62, v44, v45
    v_cvt_pk_bf16_f32 v63, v46, v47
    s_waitcnt lgkmcnt(0)
    v_mfma_f32_32x32x16_bf16 v[64:79], v[160:163], v[56:59], v[64:79]
    v_mfma_f32_32x32x16_bf16 v[64:79], v[164:167], v[60:63], v[64:79]
    ds_read_b128 v[146:149], v207 offset:1536
    ds_read_b64 v[150:151], v208 offset:1536
    ds_read_b64_tr_b16 v[160:161], v209 offset:1536
    ds_read_b64_tr_b16 v[162:163], v209 offset:1664
    ds_read_b64_tr_b16 v[164:165], v209 offset:1792
    ds_read_b64_tr_b16 v[166:167], v209 offset:1920
    s_waitcnt lgkmcnt(4)
    v_mfma_f32_32x32x16_bf16 v[16:31], v[146:149], v[134:137], 0
    v_mfma_f32_32x32x8_bf16 v[16:31], v[150:151], v[138:139], v[16:31]
    s_nop 15
    v_sub_f32 v16, v16, v169
    v_min_f32 v16, 0, v16
    v_exp_f32 v16, v16
    v_sub_f32 v17, v17, v169
    v_min_f32 v17, 0, v17
    v_exp_f32 v17, v17
    v_sub_f32 v18, v18, v169
    v_min_f32 v18, 0, v18
    v_exp_f32 v18, v18
    v_sub_f32 v19, v19, v169
    v_min_f32 v19, 0, v19
    v_exp_f32 v19, v19
    v_sub_f32 v20, v20, v169
    v_min_f32 v20, 0, v20
    v_exp_f32 v20, v20
    v_sub_f32 v21, v21, v169
    v_min_f32 v21, 0, v21
    v_exp_f32 v21, v21
    v_sub_f32 v22, v22, v169
    v_min_f32 v22, 0, v22
    v_exp_f32 v22, v22
    v_sub_f32 v23, v23, v169
    v_min_f32 v23, 0, v23
    v_exp_f32 v23, v23
    v_sub_f32 v24, v24, v169
    v_min_f32 v24, 0, v24
    v_exp_f32 v24, v24
    v_sub_f32 v25, v25, v169
    v_min_f32 v25, 0, v25
    v_exp_f32 v25, v25
    v_sub_f32 v26, v26, v169
    v_min_f32 v26, 0, v26
    v_exp_f32 v26, v26
    v_sub_f32 v27, v27, v169
    v_min_f32 v27, 0, v27
    v_exp_f32 v27, v27
    v_sub_f32 v28, v28, v169
    v_min_f32 v28, 0, v28
    v_exp_f32 v28, v28
    v_sub_f32 v29, v29, v169
    v_min_f32 v29, 0, v29
    v_exp_f32 v29, v29
    v_sub_f32 v30, v30, v169
    v_min_f32 v30, 0, v30
    v_exp_f32 v30, v30
    v_sub_f32 v31, v31, v169
    v_min_f32 v31, 0, v31
    v_exp_f32 v31, v31
    v_cvt_pk_bf16_f32 v48, v16, v17
    v_cvt_pk_bf16_f32 v49, v18, v19
    v_cvt_pk_bf16_f32 v50, v20, v21
    v_cvt_pk_bf16_f32 v51, v22, v23
    v_cvt_pk_bf16_f32 v52, v24, v25
    v_cvt_pk_bf16_f32 v53, v26, v27
    v_cvt_pk_bf16_f32 v54, v28, v29
    v_cvt_pk_bf16_f32 v55, v30, v31
    s_waitcnt lgkmcnt(0)
    v_mfma_f32_32x32x16_bf16 v[80:95], v[160:163], v[48:51], v[80:95]
    v_mfma_f32_32x32x16_bf16 v[80:95], v[164:167], v[52:55], v[80:95]
    ds_read_b128 v[140:143], v207 offset:2048
    ds_read_b64 v[144:145], v208 offset:2048
    ds_read_b64_tr_b16 v[152:153], v209 offset:2048
    ds_read_b64_tr_b16 v[154:155], v209 offset:2176
    ds_read_b64_tr_b16 v[156:157], v209 offset:2304
    ds_read_b64_tr_b16 v[158:159], v209 offset:2432
    s_waitcnt lgkmcnt(4)
    v_mfma_f32_32x32x16_bf16 v[32:47], v[140:143], v[128:131], 0
    v_mfma_f32_32x32x8_bf16 v[32:47], v[144:145], v[132:133], v[32:47]
    s_nop 15
    v_sub_f32 v32, v32, v168
    v_min_f32 v32, 0, v32
    v_exp_f32 v32, v32
    v_sub_f32 v33, v33, v168
    v_min_f32 v33, 0, v33
    v_exp_f32 v33, v33
    v_sub_f32 v34, v34, v168
    v_min_f32 v34, 0, v34
    v_exp_f32 v34, v34
    v_sub_f32 v35, v35, v168
    v_min_f32 v35, 0, v35
    v_exp_f32 v35, v35
    v_sub_f32 v36, v36, v168
    v_min_f32 v36, 0, v36
    v_exp_f32 v36, v36
    v_sub_f32 v37, v37, v168
    v_min_f32 v37, 0, v37
    v_exp_f32 v37, v37
    v_sub_f32 v38, v38, v168
    v_min_f32 v38, 0, v38
    v_exp_f32 v38, v38
    v_sub_f32 v39, v39, v168
    v_min_f32 v39, 0, v39
    v_exp_f32 v39, v39
    v_sub_f32 v40, v40, v168
    v_min_f32 v40, 0, v40
    v_exp_f32 v40, v40
    v_sub_f32 v41, v41, v168
    v_min_f32 v41, 0, v41
    v_exp_f32 v41, v41
    v_sub_f32 v42, v42, v168
    v_min_f32 v42, 0, v42
    v_exp_f32 v42, v42
    v_sub_f32 v43, v43, v168
    v_min_f32 v43, 0, v43
    v_exp_f32 v43, v43
    v_sub_f32 v44, v44, v168
    v_min_f32 v44, 0, v44
    v_exp_f32 v44, v44
    v_sub_f32 v45, v45, v168
    v_min_f32 v45, 0, v45
    v_exp_f32 v45, v45
    v_sub_f32 v46, v46, v168
    v_min_f32 v46, 0, v46
    v_exp_f32 v46, v46
    v_sub_f32 v47, v47, v168
    v_min_f32 v47, 0, v47
    v_exp_f32 v47, v47
    v_cvt_pk_bf16_f32 v56, v32, v33
    v_cvt_pk_bf16_f32 v57, v34, v35
    v_cvt_pk_bf16_f32 v58, v36, v37
    v_cvt_pk_bf16_f32 v59, v38, v39
    v_cvt_pk_bf16_f32 v60, v40, v41
    v_cvt_pk_bf16_f32 v61, v42, v43
    v_cvt_pk_bf16_f32 v62, v44, v45
    v_cvt_pk_bf16_f32 v63, v46, v47
    s_waitcnt lgkmcnt(0)
    v_mfma_f32_32x32x16_bf16 v[64:79], v[152:155], v[56:59], v[64:79]
    v_mfma_f32_32x32x16_bf16 v[64:79], v[156:159], v[60:63], v[64:79]
    ds_read_b128 v[140:143], v207 offset:2048
    ds_read_b64 v[144:145], v208 offset:2048
    ds_read_b64_tr_b16 v[152:153], v209 offset:2048
    ds_read_b64_tr_b16 v[154:155], v209 offset:2176
    ds_read_b64_tr_b16 v[156:157], v209 offset:2304
    ds_read_b64_tr_b16 v[158:159], v209 offset:2432
    s_waitcnt lgkmcnt(4)
    v_mfma_f32_32x32x16_bf16 v[16:31], v[140:143], v[134:137], 0
    v_mfma_f32_32x32x8_bf16 v[16:31], v[144:145], v[138:139], v[16:31]
    s_nop 15
    v_sub_f32 v16, v16, v169
    v_min_f32 v16, 0, v16
    v_exp_f32 v16, v16
    v_sub_f32 v17, v17, v169
    v_min_f32 v17, 0, v17
    v_exp_f32 v17, v17
    v_sub_f32 v18, v18, v169
    v_min_f32 v18, 0, v18
    v_exp_f32 v18, v18
    v_sub_f32 v19, v19, v169
    v_min_f32 v19, 0, v19
    v_exp_f32 v19, v19
    v_sub_f32 v20, v20, v169
    v_min_f32 v20, 0, v20
    v_exp_f32 v20, v20
    v_sub_f32 v21, v21, v169
    v_min_f32 v21, 0, v21
    v_exp_f32 v21, v21
    v_sub_f32 v22, v22, v169
    v_min_f32 v22, 0, v22
    v_exp_f32 v22, v22
    v_sub_f32 v23, v23, v169
    v_min_f32 v23, 0, v23
    v_exp_f32 v23, v23
    v_sub_f32 v24, v24, v169
    v_min_f32 v24, 0, v24
    v_exp_f32 v24, v24
    v_sub_f32 v25, v25, v169
    v_min_f32 v25, 0, v25
    v_exp_f32 v25, v25
    v_sub_f32 v26, v26, v169
    v_min_f32 v26, 0, v26
    v_exp_f32 v26, v26
    v_sub_f32 v27, v27, v169
    v_min_f32 v27, 0, v27
    v_exp_f32 v27, v27
    v_sub_f32 v28, v28, v169
    v_min_f32 v28, 0, v28
    v_exp_f32 v28, v28
    v_sub_f32 v29, v29, v169
    v_min_f32 v29, 0, v29
    v_exp_f32 v29, v29
    v_sub_f32 v30, v30, v169
    v_min_f32 v30, 0, v30
    v_exp_f32 v30, v30
    v_sub_f32 v31, v31, v169
    v_min_f32 v31, 0, v31
    v_exp_f32 v31, v31
    v_cvt_pk_bf16_f32 v48, v16, v17
    v_cvt_pk_bf16_f32 v49, v18, v19
    v_cvt_pk_bf16_f32 v50, v20, v21
    v_cvt_pk_bf16_f32 v51, v22, v23
    v_cvt_pk_bf16_f32 v52, v24, v25
    v_cvt_pk_bf16_f32 v53, v26, v27
    v_cvt_pk_bf16_f32 v54, v28, v29
    v_cvt_pk_bf16_f32 v55, v30, v31
    s_waitcnt lgkmcnt(0)
    v_mfma_f32_32x32x16_bf16 v[80:95], v[152:155], v[48:51], v[80:95]
    v_mfma_f32_32x32x16_bf16 v[80:95], v[156:159], v[52:55], v[80:95]
    ds_read_b128 v[146:149], v207 offset:2560
    ds_read_b64 v[150:151], v208 offset:2560
    ds_read_b64_tr_b16 v[160:161], v209 offset:2560
    ds_read_b64_tr_b16 v[162:163], v209 offset:2688
    ds_read_b64_tr_b16 v[164:165], v209 offset:2816
    ds_read_b64_tr_b16 v[166:167], v209 offset:2944
    s_waitcnt lgkmcnt(4)
    v_mfma_f32_32x32x16_bf16 v[32:47], v[146:149], v[128:131], 0
    v_mfma_f32_32x32x8_bf16 v[32:47], v[150:151], v[132:133], v[32:47]
    s_nop 15
    v_sub_f32 v32, v32, v168
    v_min_f32 v32, 0, v32
    v_exp_f32 v32, v32
    v_sub_f32 v33, v33, v168
    v_min_f32 v33, 0, v33
    v_exp_f32 v33, v33
    v_sub_f32 v34, v34, v168
    v_min_f32 v34, 0, v34
    v_exp_f32 v34, v34
    v_sub_f32 v35, v35, v168
    v_min_f32 v35, 0, v35
    v_exp_f32 v35, v35
    v_sub_f32 v36, v36, v168
    v_min_f32 v36, 0, v36
    v_exp_f32 v36, v36
    v_sub_f32 v37, v37, v168
    v_min_f32 v37, 0, v37
    v_exp_f32 v37, v37
    v_sub_f32 v38, v38, v168
    v_min_f32 v38, 0, v38
    v_exp_f32 v38, v38
    v_sub_f32 v39, v39, v168
    v_min_f32 v39, 0, v39
    v_exp_f32 v39, v39
    v_sub_f32 v40, v40, v168
    v_min_f32 v40, 0, v40
    v_exp_f32 v40, v40
    v_sub_f32 v41, v41, v168
    v_min_f32 v41, 0, v41
    v_exp_f32 v41, v41
    v_sub_f32 v42, v42, v168
    v_min_f32 v42, 0, v42
    v_exp_f32 v42, v42
    v_sub_f32 v43, v43, v168
    v_min_f32 v43, 0, v43
    v_exp_f32 v43, v43
    v_sub_f32 v44, v44, v168
    v_min_f32 v44, 0, v44
    v_exp_f32 v44, v44
    v_sub_f32 v45, v45, v168
    v_min_f32 v45, 0, v45
    v_exp_f32 v45, v45
    v_sub_f32 v46, v46, v168
    v_min_f32 v46, 0, v46
    v_exp_f32 v46, v46
    v_sub_f32 v47, v47, v168
    v_min_f32 v47, 0, v47
    v_exp_f32 v47, v47
    v_cvt_pk_bf16_f32 v56, v32, v33
    v_cvt_pk_bf16_f32 v57, v34, v35
    v_cvt_pk_bf16_f32 v58, v36, v37
    v_cvt_pk_bf16_f32 v59, v38, v39
    v_cvt_pk_bf16_f32 v60, v40, v41
    v_cvt_pk_bf16_f32 v61, v42, v43
    v_cvt_pk_bf16_f32 v62, v44, v45
    v_cvt_pk_bf16_f32 v63, v46, v47
    s_waitcnt lgkmcnt(0)
    v_mfma_f32_32x32x16_bf16 v[64:79], v[160:163], v[56:59], v[64:79]
    v_mfma_f32_32x32x16_bf16 v[64:79], v[164:167], v[60:63], v[64:79]
    ds_read_b128 v[146:149], v207 offset:2560
    ds_read_b64 v[150:151], v208 offset:2560
    ds_read_b64_tr_b16 v[160:161], v209 offset:2560
    ds_read_b64_tr_b16 v[162:163], v209 offset:2688
    ds_read_b64_tr_b16 v[164:165], v209 offset:2816
    ds_read_b64_tr_b16 v[166:167], v209 offset:2944
    s_waitcnt lgkmcnt(4)
    v_mfma_f32_32x32x16_bf16 v[16:31], v[146:149], v[134:137], 0
    v_mfma_f32_32x32x8_bf16 v[16:31], v[150:151], v[138:139], v[16:31]
    s_nop 15
    v_sub_f32 v16, v16, v169
    v_min_f32 v16, 0, v16
    v_exp_f32 v16, v16
    v_sub_f32 v17, v17, v169
    v_min_f32 v17, 0, v17
    v_exp_f32 v17, v17
    v_sub_f32 v18, v18, v169
    v_min_f32 v18, 0, v18
    v_exp_f32 v18, v18
    v_sub_f32 v19, v19, v169
    v_min_f32 v19, 0, v19
    v_exp_f32 v19, v19
    v_sub_f32 v20, v20, v169
    v_min_f32 v20, 0, v20
    v_exp_f32 v20, v20
    v_sub_f32 v21, v21, v169
    v_min_f32 v21, 0, v21
    v_exp_f32 v21, v21
    v_sub_f32 v22, v22, v169
    v_min_f32 v22, 0, v22
    v_exp_f32 v22, v22
    v_sub_f32 v23, v23, v169
    v_min_f32 v23, 0, v23
    v_exp_f32 v23, v23
    v_sub_f32 v24, v24, v169
    v_min_f32 v24, 0, v24
    v_exp_f32 v24, v24
    v_sub_f32 v25, v25, v169
    v_min_f32 v25, 0, v25
    v_exp_f32 v25, v25
    v_sub_f32 v26, v26, v169
    v_min_f32 v26, 0, v26
    v_exp_f32 v26, v26
    v_sub_f32 v27, v27, v169
    v_min_f32 v27, 0, v27
    v_exp_f32 v27, v27
    v_sub_f32 v28, v28, v169
    v_min_f32 v28, 0, v28
    v_exp_f32 v28, v28
    v_sub_f32 v29, v29, v169
    v_min_f32 v29, 0, v29
    v_exp_f32 v29, v29
    v_sub_f32 v30, v30, v169
    v_min_f32 v30, 0, v30
    v_exp_f32 v30, v30
    v_sub_f32 v31, v31, v169
    v_min_f32 v31, 0, v31
    v_exp_f32 v31, v31
    v_cvt_pk_bf16_f32 v48, v16, v17
    v_cvt_pk_bf16_f32 v49, v18, v19
    v_cvt_pk_bf16_f32 v50, v20, v21
    v_cvt_pk_bf16_f32 v51, v22, v23
    v_cvt_pk_bf16_f32 v52, v24, v25
    v_cvt_pk_bf16_f32 v53, v26, v27
    v_cvt_pk_bf16_f32 v54, v28, v29
    v_cvt_pk_bf16_f32 v55, v30, v31
    s_waitcnt lgkmcnt(0)
    v_mfma_f32_32x32x16_bf16 v[80:95], v[160:163], v[48:51], v[80:95]
    v_mfma_f32_32x32x16_bf16 v[80:95], v[164:167], v[52:55], v[80:95]
    ds_read_b128 v[140:143], v207 offset:3072
    ds_read_b64 v[144:145], v208 offset:3072
    ds_read_b64_tr_b16 v[152:153], v209 offset:3072
    ds_read_b64_tr_b16 v[154:155], v209 offset:3200
    ds_read_b64_tr_b16 v[156:157], v209 offset:3328
    ds_read_b64_tr_b16 v[158:159], v209 offset:3456
    s_waitcnt lgkmcnt(4)
    v_mfma_f32_32x32x16_bf16 v[32:47], v[140:143], v[128:131], 0
    v_mfma_f32_32x32x8_bf16 v[32:47], v[144:145], v[132:133], v[32:47]
    s_nop 15
    v_sub_f32 v32, v32, v168
    v_min_f32 v32, 0, v32
    v_exp_f32 v32, v32
    v_sub_f32 v33, v33, v168
    v_min_f32 v33, 0, v33
    v_exp_f32 v33, v33
    v_sub_f32 v34, v34, v168
    v_min_f32 v34, 0, v34
    v_exp_f32 v34, v34
    v_sub_f32 v35, v35, v168
    v_min_f32 v35, 0, v35
    v_exp_f32 v35, v35
    v_sub_f32 v36, v36, v168
    v_min_f32 v36, 0, v36
    v_exp_f32 v36, v36
    v_sub_f32 v37, v37, v168
    v_min_f32 v37, 0, v37
    v_exp_f32 v37, v37
    v_sub_f32 v38, v38, v168
    v_min_f32 v38, 0, v38
    v_exp_f32 v38, v38
    v_sub_f32 v39, v39, v168
    v_min_f32 v39, 0, v39
    v_exp_f32 v39, v39
    v_sub_f32 v40, v40, v168
    v_min_f32 v40, 0, v40
    v_exp_f32 v40, v40
    v_sub_f32 v41, v41, v168
    v_min_f32 v41, 0, v41
    v_exp_f32 v41, v41
    v_sub_f32 v42, v42, v168
    v_min_f32 v42, 0, v42
    v_exp_f32 v42, v42
    v_sub_f32 v43, v43, v168
    v_min_f32 v43, 0, v43
    v_exp_f32 v43, v43
    v_sub_f32 v44, v44, v168
    v_min_f32 v44, 0, v44
    v_exp_f32 v44, v44
    v_sub_f32 v45, v45, v168
    v_min_f32 v45, 0, v45
    v_exp_f32 v45, v45
    v_sub_f32 v46, v46, v168
    v_min_f32 v46, 0, v46
    v_exp_f32 v46, v46
    v_sub_f32 v47, v47, v168
    v_min_f32 v47, 0, v47
    v_exp_f32 v47, v47
    v_cvt_pk_bf16_f32 v56, v32, v33
    v_cvt_pk_bf16_f32 v57, v34, v35
    v_cvt_pk_bf16_f32 v58, v36, v37
    v_cvt_pk_bf16_f32 v59, v38, v39
    v_cvt_pk_bf16_f32 v60, v40, v41
    v_cvt_pk_bf16_f32 v61, v42, v43
    v_cvt_pk_bf16_f32 v62, v44, v45
    v_cvt_pk_bf16_f32 v63, v46, v47
    s_waitcnt lgkmcnt(0)
    v_mfma_f32_32x32x16_bf16 v[64:79], v[152:155], v[56:59], v[64:79]
    v_mfma_f32_32x32x16_bf16 v[64:79], v[156:159], v[60:63], v[64:79]
    ds_read_b128 v[140:143], v207 offset:3072
    ds_read_b64 v[144:145], v208 offset:3072
    ds_read_b64_tr_b16 v[152:153], v209 offset:3072
    ds_read_b64_tr_b16 v[154:155], v209 offset:3200
    ds_read_b64_tr_b16 v[156:157], v209 offset:3328
    ds_read_b64_tr_b16 v[158:159], v209 offset:3456
    s_waitcnt lgkmcnt(4)
    v_mfma_f32_32x32x16_bf16 v[16:31], v[140:143], v[134:137], 0
    v_mfma_f32_32x32x8_bf16 v[16:31], v[144:145], v[138:139], v[16:31]
    s_nop 15
    v_sub_f32 v16, v16, v169
    v_min_f32 v16, 0, v16
    v_exp_f32 v16, v16
    v_sub_f32 v17, v17, v169
    v_min_f32 v17, 0, v17
    v_exp_f32 v17, v17
    v_sub_f32 v18, v18, v169
    v_min_f32 v18, 0, v18
    v_exp_f32 v18, v18
    v_sub_f32 v19, v19, v169
    v_min_f32 v19, 0, v19
    v_exp_f32 v19, v19
    v_sub_f32 v20, v20, v169
    v_min_f32 v20, 0, v20
    v_exp_f32 v20, v20
    v_sub_f32 v21, v21, v169
    v_min_f32 v21, 0, v21
    v_exp_f32 v21, v21
    v_sub_f32 v22, v22, v169
    v_min_f32 v22, 0, v22
    v_exp_f32 v22, v22
    v_sub_f32 v23, v23, v169
    v_min_f32 v23, 0, v23
    v_exp_f32 v23, v23
    v_sub_f32 v24, v24, v169
    v_min_f32 v24, 0, v24
    v_exp_f32 v24, v24
    v_sub_f32 v25, v25, v169
    v_min_f32 v25, 0, v25
    v_exp_f32 v25, v25
    v_sub_f32 v26, v26, v169
    v_min_f32 v26, 0, v26
    v_exp_f32 v26, v26
    v_sub_f32 v27, v27, v169
    v_min_f32 v27, 0, v27
    v_exp_f32 v27, v27
    v_sub_f32 v28, v28, v169
    v_min_f32 v28, 0, v28
    v_exp_f32 v28, v28
    v_sub_f32 v29, v29, v169
    v_min_f32 v29, 0, v29
    v_exp_f32 v29, v29
    v_sub_f32 v30, v30, v169
    v_min_f32 v30, 0, v30
    v_exp_f32 v30, v30
    v_sub_f32 v31, v31, v169
    v_min_f32 v31, 0, v31
    v_exp_f32 v31, v31
    v_cvt_pk_bf16_f32 v48, v16, v17
    v_cvt_pk_bf16_f32 v49, v18, v19
    v_cvt_pk_bf16_f32 v50, v20, v21
    v_cvt_pk_bf16_f32 v51, v22, v23
    v_cvt_pk_bf16_f32 v52, v24, v25
    v_cvt_pk_bf16_f32 v53, v26, v27
    v_cvt_pk_bf16_f32 v54, v28, v29
    v_cvt_pk_bf16_f32 v55, v30, v31
    s_waitcnt lgkmcnt(0)
    v_mfma_f32_32x32x16_bf16 v[80:95], v[152:155], v[48:51], v[80:95]
    v_mfma_f32_32x32x16_bf16 v[80:95], v[156:159], v[52:55], v[80:95]
    ds_read_b128 v[146:149], v207 offset:3584
    ds_read_b64 v[150:151], v208 offset:3584
    ds_read_b64_tr_b16 v[160:161], v209 offset:3584
    ds_read_b64_tr_b16 v[162:163], v209 offset:3712
    ds_read_b64_tr_b16 v[164:165], v209 offset:3840
    ds_read_b64_tr_b16 v[166:167], v209 offset:3968
    s_waitcnt lgkmcnt(4)
    v_mfma_f32_32x32x16_bf16 v[32:47], v[146:149], v[128:131], 0
    v_mfma_f32_32x32x8_bf16 v[32:47], v[150:151], v[132:133], v[32:47]
    s_nop 15
    v_sub_f32 v32, v32, v168
    v_min_f32 v32, 0, v32
    v_exp_f32 v32, v32
    v_sub_f32 v33, v33, v168
    v_min_f32 v33, 0, v33
    v_exp_f32 v33, v33
    v_sub_f32 v34, v34, v168
    v_min_f32 v34, 0, v34
    v_exp_f32 v34, v34
    v_sub_f32 v35, v35, v168
    v_min_f32 v35, 0, v35
    v_exp_f32 v35, v35
    v_sub_f32 v36, v36, v168
    v_min_f32 v36, 0, v36
    v_exp_f32 v36, v36
    v_sub_f32 v37, v37, v168
    v_min_f32 v37, 0, v37
    v_exp_f32 v37, v37
    v_sub_f32 v38, v38, v168
    v_min_f32 v38, 0, v38
    v_exp_f32 v38, v38
    v_sub_f32 v39, v39, v168
    v_min_f32 v39, 0, v39
    v_exp_f32 v39, v39
    v_sub_f32 v40, v40, v168
    v_min_f32 v40, 0, v40
    v_exp_f32 v40, v40
    v_sub_f32 v41, v41, v168
    v_min_f32 v41, 0, v41
    v_exp_f32 v41, v41
    v_sub_f32 v42, v42, v168
    v_min_f32 v42, 0, v42
    v_exp_f32 v42, v42
    v_sub_f32 v43, v43, v168
    v_min_f32 v43, 0, v43
    v_exp_f32 v43, v43
    v_sub_f32 v44, v44, v168
    v_min_f32 v44, 0, v44
    v_exp_f32 v44, v44
    v_sub_f32 v45, v45, v168
    v_min_f32 v45, 0, v45
    v_exp_f32 v45, v45
    v_sub_f32 v46, v46, v168
    v_min_f32 v46, 0, v46
    v_exp_f32 v46, v46
    v_sub_f32 v47, v47, v168
    v_min_f32 v47, 0, v47
    v_exp_f32 v47, v47
    v_cvt_pk_bf16_f32 v56, v32, v33
    v_cvt_pk_bf16_f32 v57, v34, v35
    v_cvt_pk_bf16_f32 v58, v36, v37
    v_cvt_pk_bf16_f32 v59, v38, v39
    v_cvt_pk_bf16_f32 v60, v40, v41
    v_cvt_pk_bf16_f32 v61, v42, v43
    v_cvt_pk_bf16_f32 v62, v44, v45
    v_cvt_pk_bf16_f32 v63, v46, v47
    s_waitcnt lgkmcnt(0)
    v_mfma_f32_32x32x16_bf16 v[64:79], v[160:163], v[56:59], v[64:79]
    v_mfma_f32_32x32x16_bf16 v[64:79], v[164:167], v[60:63], v[64:79]
    ds_read_b128 v[146:149], v207 offset:3584
    ds_read_b64 v[150:151], v208 offset:3584
    ds_read_b64_tr_b16 v[160:161], v209 offset:3584
    ds_read_b64_tr_b16 v[162:163], v209 offset:3712
    ds_read_b64_tr_b16 v[164:165], v209 offset:3840
    ds_read_b64_tr_b16 v[166:167], v209 offset:3968
    s_waitcnt lgkmcnt(4)
    v_mfma_f32_32x32x16_bf16 v[16:31], v[146:149], v[134:137], 0
    v_mfma_f32_32x32x8_bf16 v[16:31], v[150:151], v[138:139], v[16:31]
    s_nop 15
    v_sub_f32 v16, v16, v169
    v_min_f32 v16, 0, v16
    v_exp_f32 v16, v16
    v_sub_f32 v17, v17, v169
    v_min_f32 v17, 0, v17
    v_exp_f32 v17, v17
    v_sub_f32 v18, v18, v169
    v_min_f32 v18, 0, v18
    v_exp_f32 v18, v18
    v_sub_f32 v19, v19, v169
    v_min_f32 v19, 0, v19
    v_exp_f32 v19, v19
    v_sub_f32 v20, v20, v169
    v_min_f32 v20, 0, v20
    v_exp_f32 v20, v20
    v_sub_f32 v21, v21, v169
    v_min_f32 v21, 0, v21
    v_exp_f32 v21, v21
    v_sub_f32 v22, v22, v169
    v_min_f32 v22, 0, v22
    v_exp_f32 v22, v22
    v_sub_f32 v23, v23, v169
    v_min_f32 v23, 0, v23
    v_exp_f32 v23, v23
    v_sub_f32 v24, v24, v169
    v_min_f32 v24, 0, v24
    v_exp_f32 v24, v24
    v_sub_f32 v25, v25, v169
    v_min_f32 v25, 0, v25
    v_exp_f32 v25, v25
    v_sub_f32 v26, v26, v169
    v_min_f32 v26, 0, v26
    v_exp_f32 v26, v26
    v_sub_f32 v27, v27, v169
    v_min_f32 v27, 0, v27
    v_exp_f32 v27, v27
    v_sub_f32 v28, v28, v169
    v_min_f32 v28, 0, v28
    v_exp_f32 v28, v28
    v_sub_f32 v29, v29, v169
    v_min_f32 v29, 0, v29
    v_exp_f32 v29, v29
    v_sub_f32 v30, v30, v169
    v_min_f32 v30, 0, v30
    v_exp_f32 v30, v30
    v_sub_f32 v31, v31, v169
    v_min_f32 v31, 0, v31
    v_exp_f32 v31, v31
    v_cvt_pk_bf16_f32 v48, v16, v17
    v_cvt_pk_bf16_f32 v49, v18, v19
    v_cvt_pk_bf16_f32 v50, v20, v21
    v_cvt_pk_bf16_f32 v51, v22, v23
    v_cvt_pk_bf16_f32 v52, v24, v25
    v_cvt_pk_bf16_f32 v53, v26, v27
    v_cvt_pk_bf16_f32 v54, v28, v29
    v_cvt_pk_bf16_f32 v55, v30, v31
    s_waitcnt lgkmcnt(0)
    v_mfma_f32_32x32x16_bf16 v[80:95], v[160:163], v[48:51], v[80:95]
    v_mfma_f32_32x32x16_bf16 v[80:95], v[164:167], v[52:55], v[80:95]
    ds_read_b128 v[140:143], v207 offset:4096
    ds_read_b64 v[144:145], v208 offset:4096
    ds_read_b64_tr_b16 v[152:153], v209 offset:4096
    ds_read_b64_tr_b16 v[154:155], v209 offset:4224
    ds_read_b64_tr_b16 v[156:157], v209 offset:4352
    ds_read_b64_tr_b16 v[158:159], v209 offset:4480
    s_waitcnt lgkmcnt(4)
    v_mfma_f32_32x32x16_bf16 v[32:47], v[140:143], v[128:131], v[96:111]
    v_mfma_f32_32x32x8_bf16 v[32:47], v[144:145], v[132:133], v[32:47]
    s_nop 15
    v_sub_f32 v32, v32, v168
    v_min_f32 v32, 0, v32
    v_exp_f32 v32, v32
    v_sub_f32 v33, v33, v168
    v_min_f32 v33, 0, v33
    v_exp_f32 v33, v33
    v_sub_f32 v34, v34, v168
    v_min_f32 v34, 0, v34
    v_exp_f32 v34, v34
    v_sub_f32 v35, v35, v168
    v_min_f32 v35, 0, v35
    v_exp_f32 v35, v35
    v_sub_f32 v36, v36, v168
    v_min_f32 v36, 0, v36
    v_exp_f32 v36, v36
    v_sub_f32 v37, v37, v168
    v_min_f32 v37, 0, v37
    v_exp_f32 v37, v37
    v_sub_f32 v38, v38, v168
    v_min_f32 v38, 0, v38
    v_exp_f32 v38, v38
    v_sub_f32 v39, v39, v168
    v_min_f32 v39, 0, v39
    v_exp_f32 v39, v39
    v_sub_f32 v40, v40, v168
    v_min_f32 v40, 0, v40
    v_exp_f32 v40, v40
    v_sub_f32 v41, v41, v168
    v_min_f32 v41, 0, v41
    v_exp_f32 v41, v41
    v_sub_f32 v42, v42, v168
    v_min_f32 v42, 0, v42
    v_exp_f32 v42, v42
    v_sub_f32 v43, v43, v168
    v_min_f32 v43, 0, v43
    v_exp_f32 v43, v43
    v_sub_f32 v44, v44, v168
    v_min_f32 v44, 0, v44
    v_exp_f32 v44, v44
    v_sub_f32 v45, v45, v168
    v_min_f32 v45, 0, v45
    v_exp_f32 v45, v45
    v_sub_f32 v46, v46, v168
    v_min_f32 v46, 0, v46
    v_exp_f32 v46, v46
    v_sub_f32 v47, v47, v168
    v_min_f32 v47, 0, v47
    v_exp_f32 v47, v47
    v_cvt_pk_bf16_f32 v56, v32, v33
    v_cvt_pk_bf16_f32 v57, v34, v35
    v_cvt_pk_bf16_f32 v58, v36, v37
    v_cvt_pk_bf16_f32 v59, v38, v39
    v_cvt_pk_bf16_f32 v60, v40, v41
    v_cvt_pk_bf16_f32 v61, v42, v43
    v_cvt_pk_bf16_f32 v62, v44, v45
    v_cvt_pk_bf16_f32 v63, v46, v47
    s_waitcnt lgkmcnt(0)
    v_mfma_f32_32x32x16_bf16 v[64:79], v[152:155], v[56:59], v[64:79]
    v_mfma_f32_32x32x16_bf16 v[64:79], v[156:159], v[60:63], v[64:79]
    ds_read_b128 v[140:143], v207 offset:4096
    ds_read_b64 v[144:145], v208 offset:4096
    ds_read_b64_tr_b16 v[152:153], v209 offset:4096
    ds_read_b64_tr_b16 v[154:155], v209 offset:4224
    ds_read_b64_tr_b16 v[156:157], v209 offset:4352
    ds_read_b64_tr_b16 v[158:159], v209 offset:4480
    s_waitcnt lgkmcnt(4)
    v_mfma_f32_32x32x16_bf16 v[16:31], v[140:143], v[134:137], 0
    v_mfma_f32_32x32x8_bf16 v[16:31], v[144:145], v[138:139], v[16:31]
    s_nop 15
    v_sub_f32 v16, v16, v169
    v_min_f32 v16, 0, v16
    v_exp_f32 v16, v16
    v_sub_f32 v17, v17, v169
    v_min_f32 v17, 0, v17
    v_exp_f32 v17, v17
    v_sub_f32 v18, v18, v169
    v_min_f32 v18, 0, v18
    v_exp_f32 v18, v18
    v_sub_f32 v19, v19, v169
    v_min_f32 v19, 0, v19
    v_exp_f32 v19, v19
    v_sub_f32 v20, v20, v169
    v_min_f32 v20, 0, v20
    v_exp_f32 v20, v20
    v_sub_f32 v21, v21, v169
    v_min_f32 v21, 0, v21
    v_exp_f32 v21, v21
    v_sub_f32 v22, v22, v169
    v_min_f32 v22, 0, v22
    v_exp_f32 v22, v22
    v_sub_f32 v23, v23, v169
    v_min_f32 v23, 0, v23
    v_exp_f32 v23, v23
    v_sub_f32 v24, v24, v169
    v_min_f32 v24, 0, v24
    v_exp_f32 v24, v24
    v_sub_f32 v25, v25, v169
    v_min_f32 v25, 0, v25
    v_exp_f32 v25, v25
    v_sub_f32 v26, v26, v169
    v_min_f32 v26, 0, v26
    v_exp_f32 v26, v26
    v_sub_f32 v27, v27, v169
    v_min_f32 v27, 0, v27
    v_exp_f32 v27, v27
    v_sub_f32 v28, v28, v169
    v_min_f32 v28, 0, v28
    v_exp_f32 v28, v28
    v_sub_f32 v29, v29, v169
    v_min_f32 v29, 0, v29
    v_exp_f32 v29, v29
    v_sub_f32 v30, v30, v169
    v_min_f32 v30, 0, v30
    v_exp_f32 v30, v30
    v_sub_f32 v31, v31, v169
    v_min_f32 v31, 0, v31
    v_exp_f32 v31, v31
    v_cvt_pk_bf16_f32 v48, v16, v17
    v_cvt_pk_bf16_f32 v49, v18, v19
    v_cvt_pk_bf16_f32 v50, v20, v21
    v_cvt_pk_bf16_f32 v51, v22, v23
    v_cvt_pk_bf16_f32 v52, v24, v25
    v_cvt_pk_bf16_f32 v53, v26, v27
    v_cvt_pk_bf16_f32 v54, v28, v29
    v_cvt_pk_bf16_f32 v55, v30, v31
    s_waitcnt lgkmcnt(0)
    v_mfma_f32_32x32x16_bf16 v[80:95], v[152:155], v[48:51], v[80:95]
    v_mfma_f32_32x32x16_bf16 v[80:95], v[156:159], v[52:55], v[80:95]
    ds_read_b128 v[146:149], v207 offset:4608
    ds_read_b64 v[150:151], v208 offset:4608
    ds_read_b64_tr_b16 v[160:161], v209 offset:4608
    ds_read_b64_tr_b16 v[162:163], v209 offset:4736
    ds_read_b64_tr_b16 v[164:165], v209 offset:4864
    ds_read_b64_tr_b16 v[166:167], v209 offset:4992
    s_waitcnt lgkmcnt(4)
    v_mfma_f32_32x32x16_bf16 v[32:47], v[146:149], v[134:137], v[96:111]
    v_mfma_f32_32x32x8_bf16 v[32:47], v[150:151], v[138:139], v[32:47]
    s_nop 15
    v_sub_f32 v32, v32, v169
    v_min_f32 v32, 0, v32
    v_exp_f32 v32, v32
    v_sub_f32 v33, v33, v169
    v_min_f32 v33, 0, v33
    v_exp_f32 v33, v33
    v_sub_f32 v34, v34, v169
    v_min_f32 v34, 0, v34
    v_exp_f32 v34, v34
    v_sub_f32 v35, v35, v169
    v_min_f32 v35, 0, v35
    v_exp_f32 v35, v35
    v_sub_f32 v36, v36, v169
    v_min_f32 v36, 0, v36
    v_exp_f32 v36, v36
    v_sub_f32 v37, v37, v169
    v_min_f32 v37, 0, v37
    v_exp_f32 v37, v37
    v_sub_f32 v38, v38, v169
    v_min_f32 v38, 0, v38
    v_exp_f32 v38, v38
    v_sub_f32 v39, v39, v169
    v_min_f32 v39, 0, v39
    v_exp_f32 v39, v39
    v_sub_f32 v40, v40, v169
    v_min_f32 v40, 0, v40
    v_exp_f32 v40, v40
    v_sub_f32 v41, v41, v169
    v_min_f32 v41, 0, v41
    v_exp_f32 v41, v41
    v_sub_f32 v42, v42, v169
    v_min_f32 v42, 0, v42
    v_exp_f32 v42, v42
    v_sub_f32 v43, v43, v169
    v_min_f32 v43, 0, v43
    v_exp_f32 v43, v43
    v_sub_f32 v44, v44, v169
    v_min_f32 v44, 0, v44
    v_exp_f32 v44, v44
    v_sub_f32 v45, v45, v169
    v_min_f32 v45, 0, v45
    v_exp_f32 v45, v45
    v_sub_f32 v46, v46, v169
    v_min_f32 v46, 0, v46
    v_exp_f32 v46, v46
    v_sub_f32 v47, v47, v169
    v_min_f32 v47, 0, v47
    v_exp_f32 v47, v47
    v_cvt_pk_bf16_f32 v56, v32, v33
    v_cvt_pk_bf16_f32 v57, v34, v35
    v_cvt_pk_bf16_f32 v58, v36, v37
    v_cvt_pk_bf16_f32 v59, v38, v39
    v_cvt_pk_bf16_f32 v60, v40, v41
    v_cvt_pk_bf16_f32 v61, v42, v43
    v_cvt_pk_bf16_f32 v62, v44, v45
    v_cvt_pk_bf16_f32 v63, v46, v47
    s_waitcnt lgkmcnt(0)
    v_mfma_f32_32x32x16_bf16 v[80:95], v[160:163], v[56:59], v[80:95]
    v_mfma_f32_32x32x16_bf16 v[80:95], v[164:167], v[60:63], v[80:95]
    s_nop 15
    s_branch .La_norm
.Ldg_40:
    buffer_store_dwordx4 v[64:67], v203, s[48:51], 0 offen sc1
    buffer_store_dwordx4 v[80:83], v203, s[48:51], 0 offen offset:512 sc1
    buffer_store_dwordx2 v[68:69], v206, s[48:51], s9 offen sc1
    s_branch .Ldd_41
.Ldg_42:
    buffer_store_dwordx4 v[250:253], v254, s[48:51], s66 offen sc1
    s_branch .Ldd_43
.Lexit:
    s_endpgm
.section .rodata,"a"
.p2align 6
.amdhsa_kernel concat_heads__sliding_block__ssm_conv_h3__prompt_kernel
  .amdhsa_next_free_vgpr 256
  .amdhsa_next_free_sgpr 102
  .amdhsa_accum_offset 256
  .amdhsa_group_segment_fixed_size 0
  .amdhsa_kernarg_size 96
  .amdhsa_user_sgpr_count 2
  .amdhsa_user_sgpr_kernarg_segment_ptr 1
  .amdhsa_system_sgpr_workgroup_id_x 1
  .amdhsa_float_denorm_mode_32 3
.end_amdhsa_kernel
```
